```python
import torch

def _softmax(x, axis=-1):
    return torch.softmax(x, dim=axis)
def _gelu(x):
    return torch.nn.functional.gelu(x, approximate="tanh")
def _silu(x):
    return torch.nn.functional.silu(x)
def _sigmoid(x):
    return torch.sigmoid(x)
def _layernorm(x, axis=-1, eps=1e-5):
    m = x.mean(dim=axis, keepdim=True)
    v = x.var(dim=axis, keepdim=True, unbiased=False)
    return (x - m) / torch.sqrt(v + eps)
def _scatter_add(tgt, idx, src, axis=0):
    return tgt.clone().index_add_(axis, idx, src)
def _segment_sum(src, seg, n):
    out = torch.zeros((n,) + src.shape[1:], dtype=src.dtype)
    return out.index_add_(0, seg, src)
def _pad(x, pw):
    flat = tuple(v for pair in reversed(pw) for v in pair)
    return torch.nn.functional.pad(x, flat)

kernel_name = 'sequential_preLN__sliding_local_dilated__dense_activation_squared_relu__prompt'

def setup_inputs():

    _w = (lambda a: (lambda t: t.to(torch.bfloat16) if t.is_floating_point() else t)(torch.as_tensor(a)))
    def _A_setup():
        B, S, D = 1, 2048, 640
        return {
            "x": _w((lambda *s: torch.randn(*s, dtype=torch.bfloat16) * 0.05)(B, S, D)),
            "wqkv": _w((lambda *s: torch.randn(*s, dtype=torch.bfloat16) * 0.05)(D, 3 * D)),
            "wo": _w((lambda *s: torch.randn(*s, dtype=torch.bfloat16) * 0.05)(D, D)),
        }
    _A_in = _A_setup()

    def _B_setup():
        B, S, D, F = 1, 2048, 640, 1536
        return {
            "x": _w((lambda *s: torch.randn(*s, dtype=torch.bfloat16) * 0.05)(B, S, D)),
            "w1": _w((lambda *s: torch.randn(*s, dtype=torch.bfloat16) * 0.05)(D, F)),
            "b1": _w((lambda *s: torch.randn(*s, dtype=torch.bfloat16) * 0.4)(F)),
            "w2": _w((lambda *s: torch.randn(*s, dtype=torch.bfloat16) * 0.05)(F, D)),
            "b2": _w((lambda *s: torch.randn(*s, dtype=torch.bfloat16) * 1.6)(D)),
        }
    _B_in = _B_setup()

    return {
        "A_x": _A_in["x"],
        "A_wqkv": _A_in["wqkv"],
        "A_wo": _A_in["wo"],
        "B_x": _B_in["x"],
        "B_w1": _B_in["w1"],
        "B_b1": _B_in["b1"],
        "B_w2": _B_in["w2"],
        "B_b2": _B_in["b2"],
    }

def reference(A_x, A_wqkv, A_wo, B_x, B_w1, B_b1, B_w2, B_b2):
    def _A_ref(x, wqkv, wo):
        B, S, D = x.shape
        H = 32; Dh = D // H
        W, dil = 8, 2
        qkv = (lambda x, *d: x.permute(*d))((x @ wqkv).reshape(B, S, 3, H, Dh), 2, 0, 3, 1, 4)
        q, k, v = qkv[0], qkv[1], qkv[2]
        scale = Dh ** -0.5
        pos = torch.arange(S)
        off = torch.arange(W) * dil
        idx = pos[:, None] - off[None, :]
        mask = idx >= 0
        idx_c = torch.where(mask, idx, 0).reshape(-1)
        kg = k[:, :, idx_c, :].reshape(B, H, S, W, Dh)
        vg = v[:, :, idx_c, :].reshape(B, H, S, W, Dh)
        logits = torch.einsum("bhsd,bhswd->bhsw", q, kg) * scale
        logits = torch.where(mask[None, None, :, :], logits, -1e9)
        attn = _softmax(logits, axis=-1)
        o = torch.einsum("bhsw,bhswd->bhsd", attn, vg)
        return (lambda x, *d: x.permute(*d))(o, 0, 2, 1, 3).reshape(B, S, D) @ wo

    def _B_ref(x, w1, b1, w2, b2):
        h = torch.einsum("bsd,df->bsf", x, w1) + b1
        zero = torch.zeros_like(h)
        r = torch.where(h > zero, h, zero)
        h = r * r
        out = torch.einsum("bsf,fd->bsd", h, w2) + b2
        return out

    x = A_x
    h = x + _A_ref(_layernorm(x, axis=-1), A_wqkv, A_wo)
    h2 = h + _B_ref(_layernorm(h, axis=-1), B_w1, B_b1, B_w2, B_b2)
    return h2
```

```asm
; @launch grid=(256,1,1) block=(768,1,1) lds=163840
.amdgcn_target "amdgcn-amd-amdhsa--gfx950"
.text
.globl sequential_preLN__sliding_local_dilated__dense_activation_squared_relu__prompt_kernel
.p2align 8
.type sequential_preLN__sliding_local_dilated__dense_activation_squared_relu__prompt_kernel,@function
sequential_preLN__sliding_local_dilated__dense_activation_squared_relu__prompt_kernel:
    s_cmp_ge_u32 s2, 256
    s_cbranch_scc1 .end_1
    s_load_dwordx16 s[16:31], s[0:1], 0
    s_load_dwordx4 s[32:35], s[0:1], 64
    s_load_dwordx2 s[36:37], s[0:1], 80
    v_lshrrev_b32 v1, 6, v0
    v_and_b32 v0, 63, v0
    v_readfirstlane_b32 s38, v1
    s_and_b32 s39, s2, 7
    s_lshr_b32 s40, s2, 3
    s_lshr_b32 s41, s40, 4
    s_lshl1_add_u32 s41, s39, s41
    s_and_b32 s42, s40, 15
    s_lshr_b32 s43, s42, 3
    s_lshl1_add_u32 s43, s41, s43
    s_and_b32 s44, s42, 7
    s_cmp_lt_u32 s38, 8
    s_cbranch_scc0 .loader_2
    v_lshlrev_b32 v1, 4, v0
    s_lshl3_add_u32 s52, s2, s38
    s_lshl3_add_u32 s53, s43, s44
    s_lshl3_add_u32 s53, s53, s38
    s_mul_i32 s54, s53, 1280
    s_mov_b32 s52, 2457536
    s_waitcnt lgkmcnt(0)
    s_load_dword s47, s[18:19], 0
    s_load_dword s47, s[18:19], s52
    s_mov_b32 s45, 29360128
    s_load_dword s45, s[36:37], s45
    s_mov_b32 s60, s16
    s_and_b32 s61, s17, 0xffff
    s_mov_b32 s62, 2621440
    s_mov_b32 s63, 0x00020000
    buffer_load_dwordx4 v[122:125], v1, s[60:63], s54 offen offset:0
    s_mov_b32 exec_lo, 0xffff
    s_mov_b32 exec_hi, 0x0
    buffer_load_dwordx4 v[122:125], v1, s[60:63], s54 offen offset:1024
    s_mov_b64 exec, -1
    s_branch .compute_3
.loader_2:
    s_setprio 3
    s_sub_u32 s52, s38, 8
    v_lshrrev_b32 v2, 3, v0
    v_lshrrev_b32 v3, 4, v0
    v_and_b32 v4, 7, v0
    v_xor_b32 v3, v3, v4
    s_lshr_b32 s53, s52, 1
    s_lshl_b32 s54, s43, 6
    s_add_u32 s54, s54, s53
    s_and_b32 s53, s52, 1
    s_lshl3_add_u32 s60, s53, s54
    s_sub_u32 s60, s60, 16
    s_lshl_b32 s53, s53, 5
    s_add_u32 s54, s54, s53
    v_lshl_add_u32 v4, v2, 1, s54
    v_lshl_add_u32 v5, v2, 1, s60
    v_mul_u32_u24 v4, 1280, v4
    v_max_i32 v5, 0, v5
    v_lshl_add_u32 v42, v3, 4, v4
    v_mul_u32_u24 v5, 1280, v5
    v_xor_b32 v43, 64, v42
    s_lshl_b32 s53, s52, 1
    v_xor_b32 v3, s53, v3
    v_add_u32 v43, 19456, v43
    v_lshl_add_u32 v44, v3, 4, v5
    s_cmp_eq_u32 s52, 0
    s_cselect_b32 s62, 0xffffff00, -1
    s_lshl_b32 s59, s52, 11
    s_add_u32 s59, s59, 33792
    s_lshl_b32 s60, s52, 9
    s_add_u32 s60, s60, 41984
    s_add_u32 s53, s43, s44
    s_and_b32 s53, s53, 3
    s_mov_b32 s64, 0x68532410
    s_mov_b32 s65, 0x97
    s_cmp_eq_u32 s53, 1
    s_cselect_b32 s64, 0x75463120, s64
    s_cselect_b32 s65, 0x89, s65
    s_cmp_eq_u32 s53, 2
    s_cselect_b32 s64, 0x96435201, s64
    s_cselect_b32 s65, 0x87, s65
    s_cmp_eq_u32 s53, 3
    s_cselect_b32 s64, 0x65742031, s64
    s_cselect_b32 s65, 0x98, s65
    s_and_b32 s57, s64, 15
    s_add_u32 s57, s57, s39
    s_sub_u32 s56, s57, 10
    s_cselect_b32 s57, s57, s56
    s_lshr_b64 s[64:65], s[64:65], 4
    s_mul_i32 s56, s57, 245760
    s_lshl_b32 s57, s57, 7
    v_and_b32 v2, 31, v0
    v_lshrrev_b32 v3, 5, v0
    v_mul_u32_u24 v4, 26, v2
    v_lshrrev_b32 v4, 8, v4
    v_mul_u32_u24 v4, 1120, v4
    v_lshl_add_u32 v4, v2, 4, v4
    v_mul_u32_u24 v5, 122880, v3
    s_mul_i32 s53, s44, 160
    s_mul_i32 s54, s52, 30720
    s_add_u32 s53, s53, s54
    v_add3_u32 v34, v4, v5, s53
    v_add_u32 v35, 2784, v34
    v_add_u32 v36, 5568, v34
    v_add_u32 v37, 8352, v34
    v_add_u32 v38, 15360, v34
    v_add_u32 v39, 18144, v34
    v_add_u32 v40, 20928, v34
    v_add_u32 v41, 23712, v34
    s_lshr_b32 s58, s52, 1
    s_lshl_b32 s58, s58, 2
    s_and_b32 s54, s52, 1
    s_add_u32 s58, s58, s54
    s_mul_i32 s58, s58, 4224
    s_mov_b32 s61, 0
    s_waitcnt lgkmcnt(0)
    s_mov_b32 s12, s16
    s_and_b32 s13, s17, 0xffff
    s_mov_b32 s14, 2621440
    s_mov_b32 s15, 0x00020000
    s_mov_b32 s8, s18
    s_and_b32 s9, s19, 0xffff
    s_mov_b32 s10, 2457600
    s_mov_b32 s11, 0x00020000
    s_add_u32 m0, s61, s59
    s_mov_b64 exec, -1
    buffer_load_dwordx4 v42, s[12:15], s57 offen lds
    buffer_load_dwordx4 v43, s[12:15], s57 offen offset:1024 lds
    s_add_u32 m0, s61, s60
    s_mov_b32 exec_lo, s62
    s_mov_b32 exec_hi, 0
    buffer_load_dwordx4 v44, s[12:15], s57 offen lds
    s_add_u32 m0, s61, s58
    s_mov_b32 exec_lo, 0x3fffffff
    s_mov_b32 exec_hi, 0x3fffffff
    buffer_load_dwordx4 v34, s[8:11], s56 offen offset:0 lds
    buffer_load_dwordx4 v35, s[8:11], s56 offen offset:1056 lds
    buffer_load_dwordx4 v36, s[8:11], s56 offen offset:2112 lds
    buffer_load_dwordx4 v37, s[8:11], s56 offen offset:3168 lds
    s_add_u32 m0, m0, 8448
    s_nop 0
    buffer_load_dwordx4 v38, s[8:11], s56 offen offset:0 lds
    buffer_load_dwordx4 v39, s[8:11], s56 offen offset:1056 lds
    buffer_load_dwordx4 v40, s[8:11], s56 offen offset:2112 lds
    buffer_load_dwordx4 v41, s[8:11], s56 offen offset:3168 lds
    s_mov_b64 exec, -1
    s_and_b32 s57, s64, 15
    s_add_u32 s57, s57, s39
    s_sub_u32 s56, s57, 10
    s_cselect_b32 s57, s57, s56
    s_lshr_b64 s[64:65], s[64:65], 4
    s_mul_i32 s56, s57, 245760
    s_lshl_b32 s57, s57, 7
    s_add_u32 s61, s61, 44032
    s_cmp_eq_u32 s61, 132096
    s_cselect_b32 s61, 0, s61
    s_mov_b32 s45, 29360128
    s_load_dword s45, s[36:37], s45
    s_add_u32 m0, s61, s59
    s_mov_b64 exec, -1
    buffer_load_dwordx4 v42, s[12:15], s57 offen lds
    buffer_load_dwordx4 v43, s[12:15], s57 offen offset:1024 lds
    s_add_u32 m0, s61, s60
    s_mov_b32 exec_lo, s62
    s_mov_b32 exec_hi, 0
    buffer_load_dwordx4 v44, s[12:15], s57 offen lds
    s_add_u32 m0, s61, s58
    s_mov_b32 exec_lo, 0x3fffffff
    s_mov_b32 exec_hi, 0x3fffffff
    buffer_load_dwordx4 v34, s[8:11], s56 offen offset:0 lds
    buffer_load_dwordx4 v35, s[8:11], s56 offen offset:1056 lds
    buffer_load_dwordx4 v36, s[8:11], s56 offen offset:2112 lds
    buffer_load_dwordx4 v37, s[8:11], s56 offen offset:3168 lds
    s_mov_b64 exec, -1
    v_and_b32 v2, 15, v0
    v_lshrrev_b32 v3, 4, v0
    v_lshrrev_b32 v4, 1, v2
    v_xor_b32 v4, v4, v3
    v_lshlrev_b32 v4, 4, v4
    v_lshl_add_u32 v4, v2, 7, v4
    v_add_u32 v88, s59, v4
    v_add_u32 v90, 41984, v4
    v_xor_b32 v89, 64, v88
    v_xor_b32 v91, 64, v90
    v_mov_b32 v84, 0x3f803f80
    v_mov_b32 v85, 0x3f803f80
    v_mov_b32 v86, 0x3f803f80
    v_mov_b32 v87, 0x3f803f80
    s_mov_b32 s79, 0
    s_mov_b32 s48, s20
    s_and_b32 s49, s21, 0xffff
    s_mov_b32 s50, 819200
    s_mov_b32 s51, 0x00020000
    s_mov_b32 s68, s28
    s_and_b32 s69, s29, 0xffff
    s_mov_b32 s70, 1966080
    s_mov_b32 s71, 0x00020000
    s_cmp_ge_u32 s2, 136
    s_cbranch_scc1 .cno_6
    s_and_b32 s76, s2, 1
    s_lshl2_add_u32 s77, s76, s52
    s_mul_i32 s76, s76, 640
    v_and_b32 v2, 7, v0
    v_lshlrev_b32 v2, 4, v2
    v_add3_u32 v2, v2, s76, 64
    v_lshrrev_b32 v3, 5, v0
    v_bfe_u32 v4, v0, 3, 2
    s_lshl_b32 s53, s52, 10
    s_add_u32 m0, s53, 156352
    s_cmp_ge_u32 s2, 40
    s_cbranch_scc1 .cw2_4
    s_lshr_b32 s53, s2, 1
    s_cmp_ge_u32 s53, 10
    s_cselect_b32 s54, 10, 0
    s_cselect_b32 s73, 320, 0
    s_sub_u32 s54, s53, s54
    s_mul_i32 s74, s54, 40
    s_mul_i32 s75, s54, 160
    s_sub_u32 s75, s75, 1264
    s_cmp_lt_u32 s54, 8
    s_cselect_b32 s74, s74, s75
    s_cselect_b32 s75, 4, 40
    s_add_u32 s73, s73, s74
    s_mul_i32 s75, s75, s52
    s_add_u32 s73, s73, s75
    s_mul_i32 s73, s73, 1280
    v_mad_u32_u24 v3, v3, 20, v4
    v_mul_u32_u24 v3, 1280, v3
    v_add_u32 v2, v2, v3
    buffer_load_dwordx4 v2, s[48:51], s73 offen offset:448 lds
    s_mul_i32 s76, s77, 20
    s_add_u32 s76, s76, 20480
    s_lshl_b32 s77, s77, 7
    s_add_u32 s77, s77, 29364224
    s_branch .cgo_5
.cw2_4:
    s_sub_u32 s53, s2, 40
    s_lshr_b32 s53, s53, 1
    s_and_b32 s74, s52, 2
    s_add_u32 s74, s74, s52
    s_lshl3_add_u32 s73, s53, s74
    s_mul_i32 s73, s73, 5120
    v_lshl_add_u32 v3, v3, 3, v4
    v_mul_u32_u24 v3, 1280, v3
    v_add_u32 v2, v2, v3
    buffer_load_dwordx4 v2, s[68:71], s73 offen offset:448 lds
    s_mul_i32 s76, s77, 48
    s_add_u32 s76, s76, 20736
    s_lshl_b32 s77, s77, 8
    s_add_u32 s77, s77, 29368320
.cgo_5:
    s_lshl2_add_u32 s77, s53, s77
    s_add_u32 s76, s76, s53
    s_lshl_b32 s76, s76, 10
    s_branch .ue_7
.cno_6:
    s_waitcnt vmcnt(7)
.ue_7:
    s_waitcnt vmcnt(8) lgkmcnt(0)
    s_barrier
    ds_read_b128 v[52:55], v88
    ds_read_b128 v[56:59], v89
    ds_read_b128 v[60:63], v90
    ds_read_b128 v[64:67], v91
    s_add_u32 m0, s61, s58
    s_mov_b32 exec_lo, 0x3fffffff
    s_mov_b32 exec_hi, 0x3fffffff
    s_add_u32 m0, m0, 8448
    s_nop 0
    buffer_load_dwordx4 v38, s[8:11], s56 offen offset:0 lds
    buffer_load_dwordx4 v39, s[8:11], s56 offen offset:1056 lds
    buffer_load_dwordx4 v40, s[8:11], s56 offen offset:2112 lds
    buffer_load_dwordx4 v41, s[8:11], s56 offen offset:3168 lds
    s_mov_b64 exec, -1
    s_and_b32 s57, s64, 15
    s_add_u32 s57, s57, s39
    s_sub_u32 s56, s57, 10
    s_cselect_b32 s57, s57, s56
    s_lshr_b64 s[64:65], s[64:65], 4
    s_mul_i32 s56, s57, 245760
    s_lshl_b32 s57, s57, 7
    s_add_u32 s61, s61, 44032
    s_cmp_eq_u32 s61, 132096
    s_cselect_b32 s61, 0, s61
    s_add_u32 m0, s61, s59
    s_mov_b64 exec, -1
    buffer_load_dwordx4 v42, s[12:15], s57 offen lds
    buffer_load_dwordx4 v43, s[12:15], s57 offen offset:1024 lds
    s_add_u32 m0, s61, s60
    s_mov_b32 exec_lo, s62
    s_mov_b32 exec_hi, 0
    buffer_load_dwordx4 v44, s[12:15], s57 offen lds
    s_mov_b64 exec, -1
    s_mov_b32 s4, s36
    s_and_b32 s5, s37, 0xffff
    s_mov_b32 s6, 33554432
    s_add_u32 m0, s61, s58
    s_mov_b32 exec_lo, 0x3fffffff
    s_mov_b32 exec_hi, 0x3fffffff
    buffer_load_dwordx4 v34, s[8:11], s56 offen offset:0 lds
    s_mov_b64 exec, -1
    s_mov_b32 s7, 0x00020000
    v_lshlrev_b32 v1, 4, v0
    v_lshrrev_b32 v2, 4, v0
    s_mov_b32 exec_lo, 0x3fffffff
    s_mov_b32 exec_hi, 0x3fffffff
    buffer_load_dwordx4 v35, s[8:11], s56 offen offset:1056 lds
    s_mov_b64 exec, -1
    v_lshlrev_b32 v2, 10, v2
    v_bfe_u32 v3, v0, 2, 2
    v_lshl_add_u32 v2, v3, 7, v2
    s_mov_b32 exec_lo, 0x3fffffff
    s_mov_b32 exec_hi, 0x3fffffff
    buffer_load_dwordx4 v36, s[8:11], s56 offen offset:2112 lds
    s_mov_b64 exec, -1
    v_and_b32 v3, 3, v0
    v_lshl_add_u32 v2, v3, 3, v2
    s_lshl_b32 s53, s52, 5
    s_mov_b32 exec_lo, 0x3fffffff
    s_mov_b32 exec_hi, 0x3fffffff
    buffer_load_dwordx4 v37, s[8:11], s56 offen offset:3168 lds
    s_mov_b64 exec, -1
    s_add_u32 s53, s53, 156800
    v_add_u32 v48, s53, v2
    v_mov_b32 v49, 161536
    s_mov_b32 exec_lo, 0x3fffffff
    s_mov_b32 exec_hi, 0x3fffffff
    s_add_u32 m0, m0, 8448
    s_nop 0
    buffer_load_dwordx4 v38, s[8:11], s56 offen offset:0 lds
    s_mov_b64 exec, -1
    s_and_b32 s45, s45, 0xfffffff8
    s_add_u32 s45, s45, 8
    v_mov_b32 v45, s45
    s_mov_b32 exec_lo, 0x3fffffff
    s_mov_b32 exec_hi, 0x3fffffff
    buffer_load_dwordx4 v39, s[8:11], s56 offen offset:1056 lds
    s_mov_b64 exec, -1
    s_mov_b32 s16, s24
    s_and_b32 s17, s25, 0xffff
    s_mov_b32 s18, 1966080
    s_mov_b64 exec, -1
    s_mov_b32 s19, 0x00020000
    s_add_u32 s79, s79, 44032
    s_cmp_eq_u32 s79, 132096
    s_cselect_b32 s79, 0, s79
    s_movk_i32 s55, 2752
    s_cmovk_i32 s55, 60032
    s_mul_i32 s55, s55, 16
    v_add_u32 v88, s55, v88
    v_add_u32 v89, s55, v89
    v_add_u32 v90, s55, v90
    v_add_u32 v91, s55, v91
    s_waitcnt lgkmcnt(0)
    v_mfma_f32_16x16x32_bf16 v[68:71], v[52:55], v[52:55], 0
    v_mfma_f32_16x16x32_bf16 v[76:79], v[84:87], v[52:55], 0
    v_mfma_f32_16x16x32_bf16 v[72:75], v[60:63], v[60:63], 0
    v_mfma_f32_16x16x32_bf16 v[80:83], v[84:87], v[60:63], 0
    v_mfma_f32_16x16x32_bf16 v[68:71], v[56:59], v[56:59], v[68:71]
    v_mfma_f32_16x16x32_bf16 v[76:79], v[84:87], v[56:59], v[76:79]
    v_mfma_f32_16x16x32_bf16 v[72:75], v[64:67], v[64:67], v[72:75]
    v_mfma_f32_16x16x32_bf16 v[80:83], v[84:87], v[64:67], v[80:83]
    s_mul_i32 s55, s2, 4
    s_add_u32 s55, s55, s52
    s_mul_i32 s55, s55, 896
    s_min_u32 s55, s55, 818304
    s_load_dword s47, s[20:21], s55 offset:0
    s_load_dword s47, s[20:21], s55 offset:64
    s_load_dword s47, s[20:21], s55 offset:128
    s_load_dword s47, s[20:21], s55 offset:192
    s_load_dword s47, s[20:21], s55 offset:256
    s_load_dword s47, s[20:21], s55 offset:320
    s_load_dword s47, s[20:21], s55 offset:384
    s_waitcnt vmcnt(9)
    s_barrier
    ds_read_b128 v[52:55], v88
    ds_read_b128 v[56:59], v89
    ds_read_b128 v[60:63], v90
    ds_read_b128 v[64:67], v91
    ds_read_b64_tr_b16 v[92:93], v48 offset:0
    ds_read_b64_tr_b16 v[94:95], v48 offset:512
    s_add_u32 m0, s61, s58
    s_mov_b32 exec_lo, 0x3fffffff
    s_mov_b32 exec_hi, 0x3fffffff
    s_add_u32 m0, m0, 8448
    s_nop 0
    buffer_load_dwordx4 v40, s[8:11], s56 offen offset:2112 lds
    buffer_load_dwordx4 v41, s[8:11], s56 offen offset:3168 lds
    s_mov_b64 exec, -1
    s_and_b32 s57, s64, 15
    s_add_u32 s57, s57, s39
    s_sub_u32 s56, s57, 10
    s_cselect_b32 s57, s57, s56
    s_lshr_b64 s[64:65], s[64:65], 4
    s_mul_i32 s56, s57, 245760
    s_lshl_b32 s57, s57, 7
    s_add_u32 s61, s61, 44032
    s_cmp_eq_u32 s61, 132096
    s_cselect_b32 s61, 0, s61
    s_add_u32 m0, s61, s59
    s_mov_b64 exec, -1
    buffer_load_dwordx4 v42, s[12:15], s57 offen lds
    buffer_load_dwordx4 v43, s[12:15], s57 offen offset:1024 lds
    s_add_u32 m0, s61, s60
    s_mov_b32 exec_lo, s62
    s_mov_b32 exec_hi, 0
    buffer_load_dwordx4 v44, s[12:15], s57 offen lds
    s_add_u32 m0, s61, s58
    s_mov_b32 exec_lo, 0x3fffffff
    s_mov_b32 exec_hi, 0x3fffffff
    buffer_load_dwordx4 v34, s[8:11], s56 offen offset:0 lds
    buffer_load_dwordx4 v35, s[8:11], s56 offen offset:1056 lds
    buffer_load_dwordx4 v36, s[8:11], s56 offen offset:2112 lds
    buffer_load_dwordx4 v37, s[8:11], s56 offen offset:3168 lds
    s_add_u32 m0, m0, 8448
    s_nop 0
    buffer_load_dwordx4 v38, s[8:11], s56 offen offset:0 lds
    buffer_load_dwordx4 v39, s[8:11], s56 offen offset:1056 lds
    buffer_load_dwordx4 v40, s[8:11], s56 offen offset:2112 lds
    buffer_load_dwordx4 v41, s[8:11], s56 offen offset:3168 lds
    s_mov_b64 exec, -1
    s_and_b32 s57, s64, 15
    s_add_u32 s57, s57, s39
    s_sub_u32 s56, s57, 10
    s_cselect_b32 s57, s57, s56
    s_lshr_b64 s[64:65], s[64:65], 4
    s_mul_i32 s56, s57, 245760
    s_lshl_b32 s57, s57, 7
    s_add_u32 s61, s61, 44032
    s_cmp_eq_u32 s61, 132096
    s_cselect_b32 s61, 0, s61
    s_add_u32 s79, s79, 44032
    s_cmp_eq_u32 s79, 132096
    s_cselect_b32 s79, 0, s79
    s_movk_i32 s55, 2752
    s_cmovk_i32 s55, 60032
    s_mul_i32 s55, s55, 16
    v_add_u32 v88, s55, v88
    v_add_u32 v89, s55, v89
    v_add_u32 v90, s55, v90
    v_add_u32 v91, s55, v91
    s_waitcnt lgkmcnt(0)
    v_mfma_f32_16x16x32_bf16 v[68:71], v[52:55], v[52:55], v[68:71]
    v_mfma_f32_16x16x32_bf16 v[76:79], v[84:87], v[52:55], v[76:79]
    v_mfma_f32_16x16x32_bf16 v[72:75], v[60:63], v[60:63], v[72:75]
    v_mfma_f32_16x16x32_bf16 v[80:83], v[84:87], v[60:63], v[80:83]
    v_mfma_f32_16x16x32_bf16 v[68:71], v[56:59], v[56:59], v[68:71]
    v_mfma_f32_16x16x32_bf16 v[76:79], v[84:87], v[56:59], v[76:79]
    v_mfma_f32_16x16x32_bf16 v[72:75], v[64:67], v[64:67], v[72:75]
    v_mfma_f32_16x16x32_bf16 v[80:83], v[84:87], v[64:67], v[80:83]
    s_mul_i32 s55, s2, 4
    s_add_u32 s55, s55, s52
    s_mul_i32 s55, s55, 896
    s_min_u32 s55, s55, 818304
    s_load_dword s47, s[20:21], s55 offset:448
    s_load_dword s47, s[20:21], s55 offset:512
    s_load_dword s47, s[20:21], s55 offset:576
    s_load_dword s47, s[20:21], s55 offset:640
    s_load_dword s47, s[20:21], s55 offset:704
    s_load_dword s47, s[20:21], s55 offset:768
    s_load_dword s47, s[20:21], s55 offset:832
    s_waitcnt vmcnt(11)
    s_barrier
    ds_read_b128 v[52:55], v88
    ds_read_b128 v[56:59], v89
    ds_read_b128 v[60:63], v90
    ds_read_b128 v[64:67], v91
    s_mov_b64 exec, -1
    s_cmp_ge_u32 s2, 136
    s_cbranch_scc1 .ev_8
    buffer_store_dwordx4 v[92:95], v1, s[4:7], s76 offen sc1
.ev_8:
    s_add_u32 m0, s61, s59
    s_mov_b64 exec, -1
    buffer_load_dwordx4 v42, s[12:15], s57 offen lds
    buffer_load_dwordx4 v43, s[12:15], s57 offen offset:1024 lds
    s_add_u32 m0, s61, s60
    s_mov_b32 exec_lo, s62
    s_mov_b32 exec_hi, 0
    buffer_load_dwordx4 v44, s[12:15], s57 offen lds
    s_mov_b64 exec, -1
    s_lshl_b32 s78, s44, 8
    s_add_u32 s78, s78, 29368320
    s_mov_b32 s54, 47
    s_lshl_b32 s53, s44, 7
    s_add_u32 s53, s53, 29364224
    s_cmp_eq_u32 s52, 1
    s_cselect_b32 s78, s53, s78
    s_cselect_b32 s54, 19, s54
    s_add_u32 m0, s61, s58
    s_mov_b32 exec_lo, 0x3fffffff
    s_mov_b32 exec_hi, 0x3fffffff
    buffer_load_dwordx4 v34, s[8:11], s56 offen offset:0 lds
    s_mov_b64 exec, -1
    s_lshl_b32 s53, s41, 6
    s_add_u32 s53, s53, 29361152
    s_cmp_eq_u32 s52, 0
    s_cselect_b32 s78, s53, s78
    s_cselect_b32 s54, 15, s54
    v_min_u32 v47, s54, v0
    v_lshlrev_b32 v47, 2, v47
    s_mov_b32 exec_lo, 0x3fffffff
    s_mov_b32 exec_hi, 0x3fffffff
    buffer_load_dwordx4 v35, s[8:11], s56 offen offset:1056 lds
    s_mov_b64 exec, -1
    s_lshr_b32 s53, s44, 2
    s_add_u32 s53, s53, s44
    s_lshl_b32 s53, s53, 7
    v_and_b32 v2, 7, v0
    v_lshlrev_b32 v2, 4, v2
    v_lshrrev_b32 v3, 5, v0
    v_bfe_u32 v4, v0, 4, 1
    s_mov_b32 exec_lo, 0x3fffffff
    s_mov_b32 exec_hi, 0x3fffffff
    buffer_load_dwordx4 v36, s[8:11], s56 offen offset:2112 lds
    s_mov_b64 exec, -1
    v_bfe_u32 v5, v0, 3, 1
    s_mul_i32 s54, s52, 2560
    s_add_u32 s54, s54, s53
    v_mul_u32_u24 v6, 409600, v3
    v_mul_u32_u24 v7, 25600, v4
    v_add3_u32 v6, v6, v7, v2
    v_mul_u32_u24 v7, 10240, v5
    s_mov_b32 exec_lo, 0x3fffffff
    s_mov_b32 exec_hi, 0x3fffffff
    buffer_load_dwordx4 v37, s[8:11], s56 offen offset:3168 lds
    s_mov_b64 exec, -1
    v_add3_u32 v6, v6, v7, s54
    v_add_u32 v7, 224, v6
    v_mul_u32_u24 v10, 983040, v3
    v_mul_u32_u24 v11, 10240, v4
    v_add3_u32 v10, v10, v11, v2
    v_mul_u32_u24 v11, 20480, v5
    v_add3_u32 v10, v10, v11, s54
    s_mov_b32 exec_lo, 0x3fffffff
    s_mov_b32 exec_hi, 0x3fffffff
    s_add_u32 m0, m0, 8448
    s_nop 0
    buffer_load_dwordx4 v38, s[8:11], s56 offen offset:0 lds
    s_mov_b64 exec, -1
    v_add_u32 v11, 224, v10
    s_lshr_b32 s53, s52, 1
    s_sub_u32 s66, s53, 1
    s_not_b32 s67, s66
    s_mul_i32 s53, s53, 46080
    s_add_u32 s54, s54, s53
    s_add_u32 s54, s54, 20480
    s_mov_b32 exec_lo, 0x3fffffff
    s_mov_b32 exec_hi, 0x3fffffff
    buffer_load_dwordx4 v39, s[8:11], s56 offen offset:1056 lds
    s_mov_b64 exec, -1
    v_mul_u32_u24 v8, 409600, v3
    v_mul_u32_u24 v9, 25600, v4
    v_add3_u32 v8, v8, v9, v2
    v_mul_u32_u24 v9, 102400, v5
    v_add3_u32 v8, v8, v9, s54
    v_add_u32 v9, 224, v8
    s_mul_i32 s53, s42, 192
    s_mov_b32 exec_lo, 0x3fffffff
    s_mov_b32 exec_hi, 0x3fffffff
    buffer_load_dwordx4 v40, s[8:11], s56 offen offset:2112 lds
    s_mov_b64 exec, -1
    s_mul_i32 s54, s52, 49152
    s_add_u32 s53, s53, s54
    s_bitcmp1_b32 s42, 0
    s_cselect_b32 s54, 64, 0
    s_cselect_b32 s73, 0, 128
    s_cselect_b32 s74, 16, 0
    s_add_u32 s54, s54, s53
    s_mov_b32 exec_lo, 0x3fffffff
    s_mov_b32 exec_hi, 0x3fffffff
    buffer_load_dwordx4 v41, s[8:11], s56 offen offset:3168 lds
    s_mov_b64 exec, -1
    s_add_u32 s53, s73, s53
    v_lshrrev_b32 v3, 3, v0
    v_mul_u32_u24 v3, 3072, v3
    v_add3_u32 v12, v3, v2, s54
    v_lshrrev_b32 v3, 2, v0
    v_mul_u32_u24 v3, 3072, v3
    v_and_b32 v2, 0x30, v2
    s_mov_b64 exec, -1
    s_and_b32 s57, s64, 15
    s_add_u32 s57, s57, s39
    s_sub_u32 s56, s57, 10
    s_cselect_b32 s57, s57, s56
    s_lshr_b64 s[64:65], s[64:65], 4
    s_mul_i32 s56, s57, 245760
    s_lshl_b32 s57, s57, 7
    s_add_u32 s61, s61, 44032
    s_cmp_eq_u32 s61, 132096
    s_cselect_b32 s61, 0, s61
    s_add_u32 s79, s79, 44032
    s_cmp_eq_u32 s79, 132096
    s_cselect_b32 s79, 0, s79
    s_movk_i32 s55, 2752
    s_cmovk_i32 s55, 60032
    s_mul_i32 s55, s55, 16
    v_add_u32 v88, s55, v88
    v_add_u32 v89, s55, v89
    v_add_u32 v90, s55, v90
    v_add_u32 v91, s55, v91
    s_waitcnt lgkmcnt(0)
    v_mfma_f32_16x16x32_bf16 v[68:71], v[52:55], v[52:55], v[68:71]
    v_mfma_f32_16x16x32_bf16 v[76:79], v[84:87], v[52:55], v[76:79]
    v_mfma_f32_16x16x32_bf16 v[72:75], v[60:63], v[60:63], v[72:75]
    v_mfma_f32_16x16x32_bf16 v[80:83], v[84:87], v[60:63], v[80:83]
    v_mfma_f32_16x16x32_bf16 v[68:71], v[56:59], v[56:59], v[68:71]
    v_mfma_f32_16x16x32_bf16 v[76:79], v[84:87], v[56:59], v[76:79]
    v_mfma_f32_16x16x32_bf16 v[72:75], v[64:67], v[64:67], v[72:75]
    v_mfma_f32_16x16x32_bf16 v[80:83], v[84:87], v[64:67], v[80:83]
    s_mul_i32 s55, s2, 4
    s_add_u32 s55, s55, s52
    s_mul_i32 s55, s55, 1920
    s_min_u32 s55, s55, 1964160
    s_load_dword s47, s[24:25], s55 offset:0
    s_load_dword s47, s[24:25], s55 offset:64
    s_load_dword s47, s[24:25], s55 offset:128
    s_load_dword s47, s[24:25], s55 offset:192
    s_load_dword s47, s[24:25], s55 offset:256
    s_load_dword s47, s[24:25], s55 offset:320
    s_load_dword s47, s[24:25], s55 offset:384
    s_cmp_lt_u32 s2, 136
    s_cbranch_scc1 .ew_9
    s_waitcnt vmcnt(11)
.ew_9:
    s_waitcnt vmcnt(12)
    s_barrier
    ds_read_b128 v[52:55], v88
    ds_read_b128 v[56:59], v89
    ds_read_b128 v[60:63], v90
    ds_read_b128 v[64:67], v91
    s_add_u32 m0, s61, s59
    s_mov_b64 exec, -1
    buffer_load_dwordx4 v42, s[12:15], s57 offen lds
    buffer_load_dwordx4 v43, s[12:15], s57 offen offset:1024 lds
    s_add_u32 m0, s61, s60
    s_mov_b32 exec_lo, s62
    s_mov_b32 exec_hi, 0
    buffer_load_dwordx4 v44, s[12:15], s57 offen lds
    s_mov_b64 exec, -1
    v_add3_u32 v13, v3, v2, s53
    v_lshlrev_b32 v4, 6, v4
    v_xor_b32 v4, v4, v1
    s_lshl_b32 s53, s52, 11
    v_add_u32 v14, s53, v4
    s_lshl_b32 s53, s52, 10
    v_add_u32 v15, s53, v1
    s_add_u32 m0, s61, s58
    s_mov_b32 exec_lo, 0x3fffffff
    s_mov_b32 exec_hi, 0x3fffffff
    buffer_load_dwordx4 v34, s[8:11], s56 offen offset:0 lds
    s_mov_b64 exec, -1
    v_add_u32 v2, s74, v0
    v_subrev_u32 v3, 48, v2
    v_min_u32 v2, v2, v3
    v_lshlrev_b32 v16, 2, v2
    v_and_b32 v2, 1, v0
    v_lshlrev_b32 v2, 4, v2
    v_lshlrev_b32 v2, v2, v84
    s_mov_b32 exec_lo, 0x3fffffff
    s_mov_b32 exec_hi, 0x3fffffff
    buffer_load_dwordx4 v35, s[8:11], s56 offen offset:1056 lds
    s_mov_b64 exec, -1
    v_bfe_u32 v3, v0, 0, 1
    v_add_u32 v3, -1, v3
    v_lshlrev_b32 v3, 16, v3
    v_bfi_b32 v2, v3, 0, v2
    v_bfe_u32 v3, v0, 1, 3
    v_cmp_eq_u32 vcc, 0, v3
    s_nop 1
    v_cndmask_b32 v22, 0, v2, vcc
    s_mov_b32 exec_lo, 0x3fffffff
    s_mov_b32 exec_hi, 0x3fffffff
    buffer_load_dwordx4 v36, s[8:11], s56 offen offset:2112 lds
    s_mov_b64 exec, -1
    v_cmp_eq_u32 vcc, 1, v3
    s_nop 1
    v_cndmask_b32 v23, 0, v2, vcc
    v_cmp_eq_u32 vcc, 2, v3
    s_nop 1
    v_cndmask_b32 v24, 0, v2, vcc
    v_cmp_eq_u32 vcc, 3, v3
    s_nop 1
    v_cndmask_b32 v25, 0, v2, vcc
    v_cmp_eq_u32 vcc, 4, v3
    s_mov_b32 exec_lo, 0x3fffffff
    s_mov_b32 exec_hi, 0x3fffffff
    buffer_load_dwordx4 v37, s[8:11], s56 offen offset:3168 lds
    s_mov_b64 exec, -1
    v_cndmask_b32 v26, 0, v2, vcc
    v_cmp_eq_u32 vcc, 5, v3
    s_nop 1
    v_cndmask_b32 v27, 0, v2, vcc
    v_cmp_eq_u32 vcc, 6, v3
    s_nop 1
    v_cndmask_b32 v28, 0, v2, vcc
    v_cmp_eq_u32 vcc, 7, v3
    s_nop 1
    v_cndmask_b32 v29, 0, v2, vcc
    s_mov_b32 exec_lo, 0x3fffffff
    s_mov_b32 exec_hi, 0x3fffffff
    s_add_u32 m0, m0, 8448
    s_nop 0
    buffer_load_dwordx4 v38, s[8:11], s56 offen offset:0 lds
    s_mov_b64 exec, -1
    v_and_b32 v2, 15, v0
    v_lshlrev_b32 v2, 5, v2
    v_and_b32 v3, 16, v0
    v_and_b32 v4, 32, v0
    v_lshl_add_u32 v3, v4, 3, v3
    s_mul_i32 s53, s52, 384
    s_add_u32 s53, s53, 156800
    s_mov_b32 exec_lo, 0x3fffffff
    s_mov_b32 exec_hi, 0x3fffffff
    buffer_load_dwordx4 v39, s[8:11], s56 offen offset:1056 lds
    s_mov_b64 exec, -1
    v_add3_u32 v17, v2, v3, s53
    s_mul_i32 s73, s52, 2112
    s_and_b32 s53, s52, 1
    s_lshl_b32 s74, s53, 10
    s_lshl1_add_u32 s53, s44, s53
    s_mul_i32 s75, s53, 10240
    s_add_u32 s75, s75, 20971520
    s_mov_b32 exec_lo, 0x3fffffff
    s_mov_b32 exec_hi, 0x3fffffff
    buffer_load_dwordx4 v40, s[8:11], s56 offen offset:2112 lds
    s_mov_b64 exec, -1
    s_mul_i32 s80, s53, 24576
    s_add_u32 s80, s80, 21233664
    s_and_b32 s53, s43, 3
    s_lshl_b32 s81, s53, 1
    s_mul_i32 s82, s53, 6
    s_and_b32 s53, s41, 1
    s_mul_i32 s83, s53, 983040
    s_mov_b32 exec_lo, 0x3fffffff
    s_mov_b32 exec_hi, 0x3fffffff
    buffer_load_dwordx4 v41, s[8:11], s56 offen offset:3168 lds
    s_mov_b64 exec, -1
    s_and_b32 s57, s64, 15
    s_add_u32 s57, s57, s39
    s_sub_u32 s56, s57, 10
    s_cselect_b32 s57, s57, s56
    s_lshr_b64 s[64:65], s[64:65], 4
    s_mul_i32 s56, s57, 245760
    s_lshl_b32 s57, s57, 7
    s_add_u32 s61, s61, 44032
    s_cmp_eq_u32 s61, 132096
    s_cselect_b32 s61, 0, s61
    s_add_u32 s79, s79, 44032
    s_cmp_eq_u32 s79, 132096
    s_cselect_b32 s79, 0, s79
    s_movk_i32 s55, 2752
    s_cmovk_i32 s55, 60032
    s_mul_i32 s55, s55, 16
    v_add_u32 v88, s55, v88
    v_add_u32 v89, s55, v89
    v_add_u32 v90, s55, v90
    v_add_u32 v91, s55, v91
    s_waitcnt lgkmcnt(0)
    v_mfma_f32_16x16x32_bf16 v[68:71], v[52:55], v[52:55], v[68:71]
    v_mfma_f32_16x16x32_bf16 v[76:79], v[84:87], v[52:55], v[76:79]
    v_mfma_f32_16x16x32_bf16 v[72:75], v[60:63], v[60:63], v[72:75]
    v_mfma_f32_16x16x32_bf16 v[80:83], v[84:87], v[60:63], v[80:83]
    v_mfma_f32_16x16x32_bf16 v[68:71], v[56:59], v[56:59], v[68:71]
    v_mfma_f32_16x16x32_bf16 v[76:79], v[84:87], v[56:59], v[76:79]
    v_mfma_f32_16x16x32_bf16 v[72:75], v[64:67], v[64:67], v[72:75]
    v_mfma_f32_16x16x32_bf16 v[80:83], v[84:87], v[64:67], v[80:83]
    s_mul_i32 s55, s2, 4
    s_add_u32 s55, s55, s52
    s_mul_i32 s55, s55, 1920
    s_min_u32 s55, s55, 1964160
    s_load_dword s47, s[24:25], s55 offset:448
    s_load_dword s47, s[24:25], s55 offset:512
    s_load_dword s47, s[24:25], s55 offset:576
    s_load_dword s47, s[24:25], s55 offset:640
    s_load_dword s47, s[24:25], s55 offset:704
    s_load_dword s47, s[24:25], s55 offset:768
    s_load_dword s47, s[24:25], s55 offset:832
    s_waitcnt vmcnt(11)
    s_barrier
    ds_read_b128 v[52:55], v88
    ds_read_b128 v[56:59], v89
    ds_read_b128 v[60:63], v90
    ds_read_b128 v[64:67], v91
    s_cmp_ge_u32 s2, 136
    s_cbranch_scc1 .ev_10
    s_mov_b64 exec, 1
    buffer_store_dword v45, off, s[4:7], s77 sc1
    s_mov_b64 exec, -1
.ev_10:
    s_add_u32 m0, s61, s59
    s_mov_b64 exec, -1
    buffer_load_dwordx4 v42, s[12:15], s57 offen lds
    buffer_load_dwordx4 v43, s[12:15], s57 offen offset:1024 lds
    s_add_u32 m0, s61, s60
    s_mov_b32 exec_lo, s62
    s_mov_b32 exec_hi, 0
    buffer_load_dwordx4 v44, s[12:15], s57 offen lds
    s_add_u32 m0, s61, s58
    s_mov_b32 exec_lo, 0x3fffffff
    s_mov_b32 exec_hi, 0x3fffffff
    buffer_load_dwordx4 v34, s[8:11], s56 offen offset:0 lds
    buffer_load_dwordx4 v35, s[8:11], s56 offen offset:1056 lds
    buffer_load_dwordx4 v36, s[8:11], s56 offen offset:2112 lds
    buffer_load_dwordx4 v37, s[8:11], s56 offen offset:3168 lds
    s_add_u32 m0, m0, 8448
    s_nop 0
    buffer_load_dwordx4 v38, s[8:11], s56 offen offset:0 lds
    buffer_load_dwordx4 v39, s[8:11], s56 offen offset:1056 lds
    buffer_load_dwordx4 v40, s[8:11], s56 offen offset:2112 lds
    buffer_load_dwordx4 v41, s[8:11], s56 offen offset:3168 lds
    s_mov_b64 exec, -1
    s_and_b32 s57, s64, 15
    s_add_u32 s57, s57, s39
    s_sub_u32 s56, s57, 10
    s_cselect_b32 s57, s57, s56
    s_lshr_b64 s[64:65], s[64:65], 4
    s_mul_i32 s56, s57, 245760
    s_lshl_b32 s57, s57, 7
    s_add_u32 s61, s61, 44032
    s_cmp_eq_u32 s61, 132096
    s_cselect_b32 s61, 0, s61
    s_add_u32 s79, s79, 44032
    s_cmp_eq_u32 s79, 132096
    s_cselect_b32 s79, 0, s79
    s_movk_i32 s55, 2752
    s_cmovk_i32 s55, 60032
    s_mul_i32 s55, s55, 16
    v_add_u32 v88, s55, v88
    v_add_u32 v89, s55, v89
    v_add_u32 v90, s55, v90
    v_add_u32 v91, s55, v91
    s_waitcnt lgkmcnt(0)
    v_mfma_f32_16x16x32_bf16 v[68:71], v[52:55], v[52:55], v[68:71]
    v_mfma_f32_16x16x32_bf16 v[76:79], v[84:87], v[52:55], v[76:79]
    v_mfma_f32_16x16x32_bf16 v[72:75], v[60:63], v[60:63], v[72:75]
    v_mfma_f32_16x16x32_bf16 v[80:83], v[84:87], v[60:63], v[80:83]
    v_mfma_f32_16x16x32_bf16 v[68:71], v[56:59], v[56:59], v[68:71]
    v_mfma_f32_16x16x32_bf16 v[76:79], v[84:87], v[56:59], v[76:79]
    v_mfma_f32_16x16x32_bf16 v[72:75], v[64:67], v[64:67], v[72:75]
    v_mfma_f32_16x16x32_bf16 v[80:83], v[84:87], v[64:67], v[80:83]
    s_mul_i32 s55, s2, 4
    s_add_u32 s55, s55, s52
    s_mul_i32 s55, s55, 1920
    s_min_u32 s55, s55, 1964160
    s_load_dword s47, s[24:25], s55 offset:896
    s_load_dword s47, s[24:25], s55 offset:960
    s_load_dword s47, s[24:25], s55 offset:1024
    s_load_dword s47, s[24:25], s55 offset:1088
    s_load_dword s47, s[24:25], s55 offset:1152
    s_load_dword s47, s[24:25], s55 offset:1216
    s_load_dword s47, s[24:25], s55 offset:1280
    s_cmp_lt_u32 s2, 136
    s_cbranch_scc1 .ew_11
    s_waitcnt vmcnt(11)
.ew_11:
    s_waitcnt vmcnt(12)
    s_barrier
    ds_read_b128 v[52:55], v88
    ds_read_b128 v[56:59], v89
    ds_read_b128 v[60:63], v90
    ds_read_b128 v[64:67], v91
    s_add_u32 m0, s61, s59
    s_mov_b64 exec, -1
    buffer_load_dwordx4 v42, s[12:15], s57 offen lds
    buffer_load_dwordx4 v43, s[12:15], s57 offen offset:1024 lds
    s_add_u32 m0, s61, s60
    s_mov_b32 exec_lo, s62
    s_mov_b32 exec_hi, 0
    buffer_load_dwordx4 v44, s[12:15], s57 offen lds
    s_add_u32 m0, s61, s58
    s_mov_b32 exec_lo, 0x3fffffff
    s_mov_b32 exec_hi, 0x3fffffff
    buffer_load_dwordx4 v34, s[8:11], s56 offen offset:0 lds
    buffer_load_dwordx4 v35, s[8:11], s56 offen offset:1056 lds
    buffer_load_dwordx4 v36, s[8:11], s56 offen offset:2112 lds
    buffer_load_dwordx4 v37, s[8:11], s56 offen offset:3168 lds
    s_add_u32 m0, m0, 8448
    s_nop 0
    buffer_load_dwordx4 v38, s[8:11], s56 offen offset:0 lds
    buffer_load_dwordx4 v39, s[8:11], s56 offen offset:1056 lds
    buffer_load_dwordx4 v40, s[8:11], s56 offen offset:2112 lds
    buffer_load_dwordx4 v41, s[8:11], s56 offen offset:3168 lds
    s_mov_b64 exec, -1
    s_and_b32 s57, s64, 15
    s_add_u32 s57, s57, s39
    s_sub_u32 s56, s57, 10
    s_cselect_b32 s57, s57, s56
    s_lshr_b64 s[64:65], s[64:65], 4
    s_mul_i32 s56, s57, 245760
    s_lshl_b32 s57, s57, 7
    s_add_u32 s61, s61, 44032
    s_cmp_eq_u32 s61, 132096
    s_cselect_b32 s61, 0, s61
    s_add_u32 s79, s79, 44032
    s_cmp_eq_u32 s79, 132096
    s_cselect_b32 s79, 0, s79
    s_movk_i32 s55, 2752
    s_cmovk_i32 s55, 60032
    s_mul_i32 s55, s55, 16
    v_add_u32 v88, s55, v88
    v_add_u32 v89, s55, v89
    v_add_u32 v90, s55, v90
    v_add_u32 v91, s55, v91
    s_waitcnt lgkmcnt(0)
    v_mfma_f32_16x16x32_bf16 v[68:71], v[52:55], v[52:55], v[68:71]
    v_mfma_f32_16x16x32_bf16 v[76:79], v[84:87], v[52:55], v[76:79]
    v_mfma_f32_16x16x32_bf16 v[72:75], v[60:63], v[60:63], v[72:75]
    v_mfma_f32_16x16x32_bf16 v[80:83], v[84:87], v[60:63], v[80:83]
    v_mfma_f32_16x16x32_bf16 v[68:71], v[56:59], v[56:59], v[68:71]
    v_mfma_f32_16x16x32_bf16 v[76:79], v[84:87], v[56:59], v[76:79]
    v_mfma_f32_16x16x32_bf16 v[72:75], v[64:67], v[64:67], v[72:75]
    v_mfma_f32_16x16x32_bf16 v[80:83], v[84:87], v[64:67], v[80:83]
    s_waitcnt vmcnt(19)
    ds_read_b128 v[52:55], v88
    ds_read_b128 v[56:59], v89
    ds_read_b128 v[60:63], v90
    ds_read_b128 v[64:67], v91
    s_add_u32 s79, s79, 44032
    s_cmp_eq_u32 s79, 132096
    s_cselect_b32 s79, 0, s79
    s_movk_i32 s55, 2752
    s_cmovk_i32 s55, 60032
    s_mul_i32 s55, s55, 16
    v_add_u32 v88, s55, v88
    v_add_u32 v89, s55, v89
    v_add_u32 v90, s55, v90
    v_add_u32 v91, s55, v91
    s_waitcnt lgkmcnt(0)
    v_mfma_f32_16x16x32_bf16 v[68:71], v[52:55], v[52:55], v[68:71]
    v_mfma_f32_16x16x32_bf16 v[76:79], v[84:87], v[52:55], v[76:79]
    v_mfma_f32_16x16x32_bf16 v[72:75], v[60:63], v[60:63], v[72:75]
    v_mfma_f32_16x16x32_bf16 v[80:83], v[84:87], v[60:63], v[80:83]
    v_mfma_f32_16x16x32_bf16 v[68:71], v[56:59], v[56:59], v[68:71]
    v_mfma_f32_16x16x32_bf16 v[76:79], v[84:87], v[56:59], v[76:79]
    v_mfma_f32_16x16x32_bf16 v[72:75], v[64:67], v[64:67], v[72:75]
    v_mfma_f32_16x16x32_bf16 v[80:83], v[84:87], v[64:67], v[80:83]
    s_mul_i32 s55, s2, 4
    s_add_u32 s55, s55, s52
    s_mul_i32 s55, s55, 1920
    s_min_u32 s55, s55, 1964160
    s_load_dword s47, s[24:25], s55 offset:1344
    s_load_dword s47, s[24:25], s55 offset:1408
    s_load_dword s47, s[24:25], s55 offset:1472
    s_load_dword s47, s[24:25], s55 offset:1536
    s_load_dword s47, s[24:25], s55 offset:1600
    s_load_dword s47, s[24:25], s55 offset:1664
    s_load_dword s47, s[24:25], s55 offset:1728
    s_waitcnt vmcnt(11)
    s_barrier
    s_waitcnt vmcnt(8)
    ds_read_b128 v[52:55], v88
    ds_read_b128 v[56:59], v89
    ds_read_b128 v[60:63], v90
    ds_read_b128 v[64:67], v91
    buffer_load_dword v46, v47, s[4:7], s78 offen sc1
    s_add_u32 m0, s61, s59
    s_mov_b64 exec, -1
    buffer_load_dwordx4 v42, s[12:15], s57 offen lds
    buffer_load_dwordx4 v43, s[12:15], s57 offen offset:1024 lds
    s_add_u32 m0, s61, s60
    s_mov_b32 exec_lo, s62
    s_mov_b32 exec_hi, 0
    buffer_load_dwordx4 v44, s[12:15], s57 offen lds
    s_add_u32 m0, s61, s58
    s_mov_b32 exec_lo, 0x3fffffff
    s_mov_b32 exec_hi, 0x3fffffff
    buffer_load_dwordx4 v34, s[8:11], s56 offen offset:0 lds
    buffer_load_dwordx4 v35, s[8:11], s56 offen offset:1056 lds
    buffer_load_dwordx4 v36, s[8:11], s56 offen offset:2112 lds
    buffer_load_dwordx4 v37, s[8:11], s56 offen offset:3168 lds
    s_add_u32 m0, m0, 8448
    s_nop 0
    buffer_load_dwordx4 v38, s[8:11], s56 offen offset:0 lds
    buffer_load_dwordx4 v39, s[8:11], s56 offen offset:1056 lds
    buffer_load_dwordx4 v40, s[8:11], s56 offen offset:2112 lds
    buffer_load_dwordx4 v41, s[8:11], s56 offen offset:3168 lds
    s_mov_b64 exec, -1
    s_and_b32 s57, s64, 15
    s_add_u32 s57, s57, s39
    s_sub_u32 s56, s57, 10
    s_cselect_b32 s57, s57, s56
    s_lshr_b64 s[64:65], s[64:65], 4
    s_mul_i32 s56, s57, 245760
    s_lshl_b32 s57, s57, 7
    s_add_u32 s61, s61, 44032
    s_cmp_eq_u32 s61, 132096
    s_cselect_b32 s61, 0, s61
    s_add_u32 s79, s79, 44032
    s_cmp_eq_u32 s79, 132096
    s_cselect_b32 s79, 0, s79
    s_movk_i32 s55, 2752
    s_cmovk_i32 s55, 60032
    s_mul_i32 s55, s55, 16
    v_add_u32 v88, s55, v88
    v_add_u32 v89, s55, v89
    v_add_u32 v90, s55, v90
    v_add_u32 v91, s55, v91
    s_waitcnt lgkmcnt(0)
    v_mfma_f32_16x16x32_bf16 v[68:71], v[52:55], v[52:55], v[68:71]
    v_mfma_f32_16x16x32_bf16 v[76:79], v[84:87], v[52:55], v[76:79]
    v_mfma_f32_16x16x32_bf16 v[72:75], v[60:63], v[60:63], v[72:75]
    v_mfma_f32_16x16x32_bf16 v[80:83], v[84:87], v[60:63], v[80:83]
    v_mfma_f32_16x16x32_bf16 v[68:71], v[56:59], v[56:59], v[68:71]
    v_mfma_f32_16x16x32_bf16 v[76:79], v[84:87], v[56:59], v[76:79]
    v_mfma_f32_16x16x32_bf16 v[72:75], v[64:67], v[64:67], v[72:75]
    v_mfma_f32_16x16x32_bf16 v[80:83], v[84:87], v[64:67], v[80:83]
    s_mul_i32 s55, s2, 4
    s_add_u32 s55, s55, s52
    s_mul_i32 s55, s55, 1920
    s_min_u32 s55, s55, 1964160
    s_load_dword s47, s[24:25], s55 offset:1792
    s_load_dword s47, s[24:25], s55 offset:1856
    s_waitcnt vmcnt(12)
    s_barrier
    s_waitcnt vmcnt(8)
    ds_read_b128 v[52:55], v88
    ds_read_b128 v[56:59], v89
    ds_read_b128 v[60:63], v90
    ds_read_b128 v[64:67], v91
    s_add_u32 m0, s61, s59
    s_mov_b64 exec, -1
    buffer_load_dwordx4 v42, s[12:15], s57 offen lds
    buffer_load_dwordx4 v43, s[12:15], s57 offen offset:1024 lds
    s_add_u32 m0, s61, s60
    s_mov_b32 exec_lo, s62
    s_mov_b32 exec_hi, 0
    buffer_load_dwordx4 v44, s[12:15], s57 offen lds
    s_add_u32 m0, s61, s58
    s_mov_b32 exec_lo, 0x3fffffff
    s_mov_b32 exec_hi, 0x3fffffff
    buffer_load_dwordx4 v34, s[8:11], s56 offen offset:0 lds
    buffer_load_dwordx4 v35, s[8:11], s56 offen offset:1056 lds
    buffer_load_dwordx4 v36, s[8:11], s56 offen offset:2112 lds
    buffer_load_dwordx4 v37, s[8:11], s56 offen offset:3168 lds
    s_add_u32 m0, m0, 8448
    s_nop 0
    buffer_load_dwordx4 v38, s[8:11], s56 offen offset:0 lds
    buffer_load_dwordx4 v39, s[8:11], s56 offen offset:1056 lds
    buffer_load_dwordx4 v40, s[8:11], s56 offen offset:2112 lds
    buffer_load_dwordx4 v41, s[8:11], s56 offen offset:3168 lds
    s_mov_b64 exec, -1
    s_and_b32 s57, s64, 15
    s_add_u32 s57, s57, s39
    s_sub_u32 s56, s57, 10
    s_cselect_b32 s57, s57, s56
    s_lshr_b64 s[64:65], s[64:65], 4
    s_mul_i32 s56, s57, 245760
    s_lshl_b32 s57, s57, 7
    s_add_u32 s61, s61, 44032
    s_cmp_eq_u32 s61, 132096
    s_cselect_b32 s61, 0, s61
    s_add_u32 s79, s79, 44032
    s_cmp_eq_u32 s79, 132096
    s_cselect_b32 s79, 0, s79
    s_movk_i32 s55, 2752
    s_cmovk_i32 s55, 60032
    s_mul_i32 s55, s55, 16
    v_add_u32 v88, s55, v88
    v_add_u32 v89, s55, v89
    v_add_u32 v90, s55, v90
    v_add_u32 v91, s55, v91
    s_waitcnt lgkmcnt(0)
    v_mfma_f32_16x16x32_bf16 v[68:71], v[52:55], v[52:55], v[68:71]
    v_mfma_f32_16x16x32_bf16 v[76:79], v[84:87], v[52:55], v[76:79]
    v_mfma_f32_16x16x32_bf16 v[72:75], v[60:63], v[60:63], v[72:75]
    v_mfma_f32_16x16x32_bf16 v[80:83], v[84:87], v[60:63], v[80:83]
    v_mfma_f32_16x16x32_bf16 v[68:71], v[56:59], v[56:59], v[68:71]
    v_mfma_f32_16x16x32_bf16 v[76:79], v[84:87], v[56:59], v[76:79]
    v_mfma_f32_16x16x32_bf16 v[72:75], v[64:67], v[64:67], v[72:75]
    v_mfma_f32_16x16x32_bf16 v[80:83], v[84:87], v[64:67], v[80:83]
    s_mov_b32 s12, s26
    s_and_b32 s13, s27, 0xffff
    s_mov_b32 s14, 3072
    s_mov_b32 s15, 0x00020000
    s_mov_b32 s47, 65536
    s_waitcnt vmcnt(11)
.chk_12:
    v_and_b32 v2, -8, v46
    v_cmp_ne_u32 vcc, s45, v2
    s_cmp_eq_u64 vcc, 0
    s_cbranch_scc1 .ok_13
    s_sub_u32 s47, s47, 1
    s_cbranch_scc1 .ok_13
    buffer_load_dword v46, v47, s[4:7], s78 offen sc1
    s_waitcnt vmcnt(0)
    s_branch .chk_12
.ok_13:
    s_barrier
    s_waitcnt vmcnt(8)
    ds_read_b128 v[52:55], v88
    ds_read_b128 v[56:59], v89
    ds_read_b128 v[60:63], v90
    ds_read_b128 v[64:67], v91
    s_cmp_lg_u32 s52, 0
    s_cbranch_scc1 .ns_14
    v_readfirstlane_b32 s53, v46
    s_nop 1
    v_cmp_ne_u32 vcc, s53, v46
    s_cmp_eq_u64 vcc, 0
    s_cselect_b32 s53, 1, 0
    v_mov_b32 v2, s53
    ds_write_b32 v49, v2
.ns_14:
    v_and_b32 v4, 3, v0
    v_and_b32 v3, 15, v0
    v_lshlrev_b32 v3, 3, v3
    v_add_u32 v5, 161408, v3
    s_lshl_b32 s53, s52, 7
    s_add_u32 s53, s53, 160896
    v_add_u32 v3, s53, v3
    v_cmp_eq_u32 s[84:85], 1, v4
    v_cmp_eq_u32 s[86:87], 2, v4
    v_cmp_eq_u32 s[88:89], 3, v4
    s_mul_i32 s53, s52, 20
    s_lshl_b64 s[64:65], 15, s53
    s_waitcnt lgkmcnt(0)
    v_mfma_f32_16x16x32_bf16 v[68:71], v[52:55], v[52:55], v[68:71]
    v_mfma_f32_16x16x32_bf16 v[76:79], v[84:87], v[52:55], v[76:79]
    v_mfma_f32_16x16x32_bf16 v[72:75], v[60:63], v[60:63], v[72:75]
    v_mfma_f32_16x16x32_bf16 v[80:83], v[84:87], v[60:63], v[80:83]
    v_mfma_f32_16x16x32_bf16 v[68:71], v[56:59], v[56:59], v[68:71]
    v_mfma_f32_16x16x32_bf16 v[76:79], v[84:87], v[56:59], v[76:79]
    v_mfma_f32_16x16x32_bf16 v[72:75], v[64:67], v[64:67], v[72:75]
    v_mfma_f32_16x16x32_bf16 v[80:83], v[84:87], v[64:67], v[80:83]
    s_nop 4
    v_cndmask_b32 v93, v68, v69, s[84:85]
    s_nop 0
    v_cndmask_b32 v95, v72, v73, s[84:85]
    v_cndmask_b32 v93, v93, v70, s[86:87]
    v_cndmask_b32 v95, v95, v74, s[86:87]
    v_cndmask_b32 v93, v93, v71, s[88:89]
    v_cndmask_b32 v95, v95, v75, s[88:89]
    v_mov_b32 v92, v76
    v_mov_b32 v94, v80
    v_mul_f32 v92, 0x3acccccd, v92
    v_mul_f32 v94, 0x3acccccd, v94
    v_mul_f32 v93, 0x3acccccd, v93
    v_mul_f32 v95, 0x3acccccd, v95
    v_fma_f32 v93, -v92, v92, v93
    v_fma_f32 v95, -v94, v94, v95
    v_max_f32 v93, 0, v93
    v_max_f32 v95, 0, v95
    v_cvt_pk_bf16_f32 v93, v93, v93
    v_cvt_pk_bf16_f32 v95, v95, v95
    v_lshlrev_b32 v93, 16, v93
    v_lshlrev_b32 v95, 16, v95
    v_add_f32 v93, 0x3727C5AC, v93
    v_add_f32 v95, 0x3727C5AC, v95
    v_cvt_pk_bf16_f32 v93, v93, v93
    v_cvt_pk_bf16_f32 v95, v95, v95
    v_lshlrev_b32 v93, 16, v93
    v_lshlrev_b32 v95, 16, v95
    v_sqrt_f32 v93, v93
    v_sqrt_f32 v95, v95
    v_cvt_pk_bf16_f32 v92, v92, v92
    v_cvt_pk_bf16_f32 v94, v94, v94
    v_lshlrev_b32 v92, 16, v92
    v_lshlrev_b32 v94, 16, v94
    v_cvt_pk_bf16_f32 v93, v93, v93
    v_cvt_pk_bf16_f32 v95, v95, v95
    v_lshlrev_b32 v93, 16, v93
    v_lshlrev_b32 v95, 16, v95
    v_rcp_f32 v96, v93
    v_rcp_f32 v97, v95
    v_mul_f32 v93, v92, v96
    v_mul_f32 v95, v94, v97
    v_mov_b32 v92, v96
    v_mov_b32 v94, v97
    s_mov_b32 exec_lo, 0x00f0000f
    s_mov_b32 exec_hi, 0xf0000f00
    ds_write_b64 v3, v[92:93]
    s_mov_b64 exec, s[64:65]
    ds_write_b64 v5, v[94:95]
    s_mov_b64 exec, -1
    s_add_u32 s53, s81, 0
    s_and_b32 s53, s53, 7
    s_lshl_b32 s54, s53, 10
    s_mul_i32 s53, s53, 51200
    s_add_u32 s54, s54, s75
    s_add_u32 m0, s73, 44032
    s_nop 0
    buffer_load_dwordx4 v6, s[48:51], s53 offen offset:0 lds
    buffer_load_dwordx4 v7, s[48:51], s53 offen offset:1056 lds
    s_add_u32 m0, s74, 52480
    s_mov_b64 exec, s[66:67]
    buffer_load_dwordx4 v1, s[4:7], s54 offen sc1 lds
    s_mov_b64 exec, -1
    s_add_u32 s53, s81, 1
    s_and_b32 s53, s53, 7
    s_lshl_b32 s54, s53, 10
    s_mul_i32 s53, s53, 51200
    s_add_u32 s54, s54, s75
    s_add_u32 m0, s73, 54528
    s_nop 0
    buffer_load_dwordx4 v6, s[48:51], s53 offen offset:0 lds
    buffer_load_dwordx4 v7, s[48:51], s53 offen offset:1056 lds
    s_add_u32 m0, s74, 62976
    s_mov_b64 exec, s[66:67]
    buffer_load_dwordx4 v1, s[4:7], s54 offen sc1 lds
    s_mov_b64 exec, -1
    s_add_u32 s53, s81, 2
    s_and_b32 s53, s53, 7
    s_lshl_b32 s54, s53, 10
    s_mul_i32 s53, s53, 51200
    s_add_u32 s54, s54, s75
    s_add_u32 m0, s73, 65024
    s_nop 0
    buffer_load_dwordx4 v6, s[48:51], s53 offen offset:0 lds
    buffer_load_dwordx4 v7, s[48:51], s53 offen offset:1056 lds
    s_add_u32 m0, s74, 73472
    s_mov_b64 exec, s[66:67]
    buffer_load_dwordx4 v1, s[4:7], s54 offen sc1 lds
    s_mov_b64 exec, -1
    s_waitcnt vmcnt(9) lgkmcnt(0)
    s_barrier
    s_setprio 0
    s_add_u32 s53, s81, 3
    s_and_b32 s53, s53, 7
    s_lshl_b32 s54, s53, 10
    s_mul_i32 s53, s53, 51200
    s_add_u32 s54, s54, s75
    s_add_u32 m0, s73, 75520
    s_nop 0
    buffer_load_dwordx4 v6, s[48:51], s53 offen offset:0 lds
    buffer_load_dwordx4 v7, s[48:51], s53 offen offset:1056 lds
    s_add_u32 m0, s74, 83968
    s_mov_b64 exec, s[66:67]
    buffer_load_dwordx4 v1, s[4:7], s54 offen sc1 lds
    s_mov_b64 exec, -1
    s_add_u32 s53, s81, 4
    s_and_b32 s53, s53, 7
    s_lshl_b32 s54, s53, 10
    s_mul_i32 s53, s53, 51200
    s_add_u32 s54, s54, s75
    s_add_u32 m0, s73, 135808
    s_nop 0
    buffer_load_dwordx4 v6, s[48:51], s53 offen offset:0 lds
    buffer_load_dwordx4 v7, s[48:51], s53 offen offset:1056 lds
    s_add_u32 m0, s74, 144256
    s_mov_b64 exec, s[66:67]
    buffer_load_dwordx4 v1, s[4:7], s54 offen sc1 lds
    s_mov_b64 exec, -1
    s_add_u32 s53, s81, 5
    s_and_b32 s53, s53, 7
    s_lshl_b32 s54, s53, 10
    s_mul_i32 s53, s53, 51200
    s_add_u32 s54, s54, s75
    s_add_u32 m0, s73, 146304
    s_nop 0
    buffer_load_dwordx4 v6, s[48:51], s53 offen offset:0 lds
    buffer_load_dwordx4 v7, s[48:51], s53 offen offset:1056 lds
    s_add_u32 m0, s74, 154752
    s_mov_b64 exec, s[66:67]
    buffer_load_dwordx4 v1, s[4:7], s54 offen sc1 lds
    s_mov_b64 exec, -1
    s_mul_i32 s53, s42, 192
    buffer_load_dword v16, v16, s[12:15], s53 offen
    s_mov_b32 s12, s30
    s_and_b32 s13, s31, 0xffff
    s_mov_b32 s14, 1280
    s_mov_b32 s15, 0x00020000
    s_lshr_b32 s53, s44, 2
    s_add_u32 s54, s53, s44
    s_lshl_b32 s54, s54, 7
    s_lshl4_add_u32 s53, s53, s44
    s_lshl_b32 s53, s53, 5
    s_add_u32 s53, s53, 384
    v_mov_b32 v2, s54
    v_mov_b32 v3, s53
    v_cmp_gt_u32 vcc, 32, v0
    s_nop 1
    v_cndmask_b32 v2, v3, v2, vcc
    v_lshl_add_u32 v2, v0, 2, v2
    s_mov_b32 m0, 161600
    s_mov_b32 exec_hi, 0xff
    buffer_load_dword v2, s[12:15], 0 offen lds
    s_mov_b64 exec, -1
    s_sub_u32 s53, 1376256, s83
    s_add_u32 s54, s53, 24576
    buffer_load_dwordx4 v[118:121], v12, s[16:19], s53 offen
    buffer_load_dwordx4 v[122:125], v12, s[16:19], s54 offen
    buffer_load_dwordx4 v[126:129], v13, s[16:19], s53 offen
    s_sub_u32 s53, 1179648, s83
    s_add_u32 s54, s53, 24576
    buffer_load_dwordx4 v[106:109], v12, s[16:19], s53 offen
    buffer_load_dwordx4 v[110:113], v12, s[16:19], s54 offen
    buffer_load_dwordx4 v[114:117], v13, s[16:19], s53 offen
    s_sub_u32 s53, 1572864, s83
    s_add_u32 s54, s53, 24576
    buffer_load_dwordx4 v[130:133], v12, s[16:19], s53 offen
    buffer_load_dwordx4 v[134:137], v12, s[16:19], s54 offen
    buffer_load_dwordx4 v[138:141], v13, s[16:19], s53 offen
    s_sub_u32 s53, 1769472, s83
    s_add_u32 s54, s53, 24576
    buffer_load_dwordx4 v[142:145], v12, s[16:19], s53 offen
    buffer_load_dwordx4 v[146:149], v12, s[16:19], s54 offen
    buffer_load_dwordx4 v[150:153], v13, s[16:19], s53 offen
    s_mul_i32 s55, s2, 4
    s_add_u32 s55, s55, s52
    s_mul_i32 s55, s55, 1920
    s_min_u32 s55, s55, 1964160
    s_load_dword s47, s[28:29], s55 offset:0
    s_load_dword s47, s[28:29], s55 offset:64
    s_load_dword s47, s[28:29], s55 offset:128
    s_load_dword s47, s[28:29], s55 offset:192
    s_load_dword s47, s[28:29], s55 offset:256
    s_load_dword s47, s[28:29], s55 offset:320
    s_load_dword s47, s[28:29], s55 offset:384
    s_load_dword s47, s[28:29], s55 offset:448
    s_barrier
    s_add_u32 s53, s81, 6
    s_and_b32 s53, s53, 7
    s_lshl_b32 s54, s53, 10
    s_mul_i32 s53, s53, 51200
    s_add_u32 s54, s54, s75
    s_add_u32 m0, s73, 0
    s_nop 0
    buffer_load_dwordx4 v6, s[48:51], s53 offen offset:0 lds
    buffer_load_dwordx4 v7, s[48:51], s53 offen offset:1056 lds
    s_add_u32 m0, s74, 8448
    s_mov_b64 exec, s[66:67]
    buffer_load_dwordx4 v1, s[4:7], s54 offen sc1 lds
    s_mov_b64 exec, -1
    s_add_u32 s53, s81, 7
    s_and_b32 s53, s53, 7
    s_lshl_b32 s54, s53, 10
    s_mul_i32 s53, s53, 51200
    s_add_u32 s54, s54, s75
    s_add_u32 m0, s73, 10496
    s_nop 0
    buffer_load_dwordx4 v6, s[48:51], s53 offen offset:0 lds
    buffer_load_dwordx4 v7, s[48:51], s53 offen offset:1056 lds
    s_add_u32 m0, s74, 18944
    s_mov_b64 exec, s[66:67]
    buffer_load_dwordx4 v1, s[4:7], s54 offen sc1 lds
    s_mov_b64 exec, -1
    s_mov_b32 s53, 0
    s_add_u32 s54, s75, 8192
    s_add_u32 m0, s73, 20992
    s_nop 0
    buffer_load_dwordx4 v8, s[48:51], s53 offen offset:0 lds
    buffer_load_dwordx4 v9, s[48:51], s53 offen offset:1056 lds
    s_add_u32 m0, s74, 29440
    s_mov_b64 exec, s[66:67]
    buffer_load_dwordx4 v1, s[4:7], s54 offen sc1 lds
    s_mov_b64 exec, -1
    s_mov_b32 s53, 204800
    s_add_u32 s54, s75, 9216
    s_add_u32 m0, s73, 31488
    s_nop 0
    buffer_load_dwordx4 v8, s[48:51], s53 offen offset:0 lds
    buffer_load_dwordx4 v9, s[48:51], s53 offen offset:1056 lds
    s_add_u32 m0, s74, 39936
    s_mov_b64 exec, s[66:67]
    buffer_load_dwordx4 v1, s[4:7], s54 offen sc1 lds
    s_mov_b64 exec, -1
    s_add_u32 s53, s83, 0
    s_add_u32 s54, s53, 24576
    buffer_load_dwordx4 v[34:37], v12, s[16:19], s53 offen
    buffer_load_dwordx4 v[38:41], v12, s[16:19], s54 offen
    buffer_load_dwordx4 v[42:45], v13, s[16:19], s53 offen
    s_mul_i32 s55, s2, 4
    s_add_u32 s55, s55, s52
    s_mul_i32 s55, s55, 1920
    s_min_u32 s55, s55, 1964160
    s_load_dword s47, s[28:29], s55 offset:512
    s_load_dword s47, s[28:29], s55 offset:576
    s_load_dword s47, s[28:29], s55 offset:640
    s_load_dword s47, s[28:29], s55 offset:704
    s_load_dword s47, s[28:29], s55 offset:768
    s_load_dword s47, s[28:29], s55 offset:832
    s_load_dword s47, s[28:29], s55 offset:896
    s_load_dword s47, s[28:29], s55 offset:960
    s_waitcnt vmcnt(3)
    s_barrier
    s_waitcnt vmcnt(24)
    v_mfma_f32_16x16x32_bf16 v[30:33], v[22:25], v[118:121], 0
    v_mfma_f32_16x16x32_bf16 v[30:33], v[22:25], v[122:125], v[30:33]
    v_mfma_f32_16x16x32_bf16 v[30:33], v[26:29], v[126:129], v[30:33]
    s_waitcnt vmcnt(21)
    v_mfma_f32_16x16x32_bf16 v[30:33], v[22:25], v[106:109], v[30:33]
    v_mfma_f32_16x16x32_bf16 v[30:33], v[22:25], v[110:113], v[30:33]
    v_mfma_f32_16x16x32_bf16 v[30:33], v[26:29], v[114:117], v[30:33]
    s_waitcnt vmcnt(18)
    v_mfma_f32_16x16x32_bf16 v[30:33], v[22:25], v[130:133], v[30:33]
    v_mfma_f32_16x16x32_bf16 v[30:33], v[22:25], v[134:137], v[30:33]
    v_mfma_f32_16x16x32_bf16 v[30:33], v[26:29], v[138:141], v[30:33]
    s_waitcnt vmcnt(15)
    v_mfma_f32_16x16x32_bf16 v[30:33], v[22:25], v[142:145], v[30:33]
    v_mfma_f32_16x16x32_bf16 v[30:33], v[22:25], v[146:149], v[30:33]
    v_mfma_f32_16x16x32_bf16 v[30:33], v[26:29], v[150:153], v[30:33]
    v_add_u32 v14, 0x1c300, v14
    v_add_u32 v15, 0x1c300, v15
    ds_write_b128 v14, v[118:121] offset:0
    ds_write_b128 v14, v[122:125] offset:1024
    ds_write_b128 v15, v[126:129] offset:8192
    s_mul_i32 s55, s2, 4
    s_add_u32 s55, s55, s52
    s_mul_i32 s55, s55, 1920
    s_min_u32 s55, s55, 1964160
    s_load_dword s47, s[28:29], s55 offset:1024
    s_load_dword s47, s[28:29], s55 offset:1088
    s_load_dword s47, s[28:29], s55 offset:1152
    s_load_dword s47, s[28:29], s55 offset:1216
    s_load_dword s47, s[28:29], s55 offset:1280
    s_load_dword s47, s[28:29], s55 offset:1344
    s_load_dword s47, s[28:29], s55 offset:1408
    s_load_dword s47, s[28:29], s55 offset:1472
    s_load_dword s47, s[28:29], s55 offset:1536
    s_load_dword s47, s[28:29], s55 offset:1600
    s_load_dword s47, s[28:29], s55 offset:1664
    s_load_dword s47, s[28:29], s55 offset:1728
    s_load_dword s47, s[28:29], s55 offset:1792
    s_load_dword s47, s[28:29], s55 offset:1856
    s_barrier
    s_add_u32 s53, s83, 196608
    s_add_u32 s54, s53, 24576
    s_waitcnt vmcnt(3)
    buffer_load_dwordx4 v[46:49], v12, s[16:19], s53 offen
    s_waitcnt vmcnt(3)
    buffer_load_dwordx4 v[50:53], v12, s[16:19], s54 offen
    s_waitcnt vmcnt(3)
    buffer_load_dwordx4 v[54:57], v13, s[16:19], s53 offen
    s_waitcnt vmcnt(3)
    v_mfma_f32_16x16x32_bf16 v[30:33], v[22:25], v[34:37], v[30:33]
    v_mfma_f32_16x16x32_bf16 v[30:33], v[22:25], v[38:41], v[30:33]
    v_mfma_f32_16x16x32_bf16 v[30:33], v[26:29], v[42:45], v[30:33]
    s_add_u32 s53, s83, 393216
    s_add_u32 s54, s53, 24576
    s_waitcnt vmcnt(3)
    buffer_load_dwordx4 v[58:61], v12, s[16:19], s53 offen
    s_waitcnt vmcnt(3)
    buffer_load_dwordx4 v[62:65], v12, s[16:19], s54 offen
    s_waitcnt vmcnt(3)
    buffer_load_dwordx4 v[66:69], v13, s[16:19], s53 offen
    s_add_u32 s53, s83, 589824
    s_add_u32 s54, s53, 24576
    buffer_load_dwordx4 v[70:73], v12, s[16:19], s53 offen
    buffer_load_dwordx4 v[74:77], v12, s[16:19], s54 offen
    buffer_load_dwordx4 v[78:81], v13, s[16:19], s53 offen
    s_add_u32 s53, s83, 786432
    s_add_u32 s54, s53, 24576
    buffer_load_dwordx4 v[82:85], v12, s[16:19], s53 offen
    buffer_load_dwordx4 v[86:89], v12, s[16:19], s54 offen
    buffer_load_dwordx4 v[90:93], v13, s[16:19], s53 offen
    s_sub_u32 s53, 983040, s83
    s_add_u32 s54, s53, 24576
    buffer_load_dwordx4 v[94:97], v12, s[16:19], s53 offen
    buffer_load_dwordx4 v[98:101], v12, s[16:19], s54 offen
    buffer_load_dwordx4 v[102:105], v13, s[16:19], s53 offen
    s_barrier
    v_add_u32 v14, 0xffff5d00, v14
    v_add_u32 v15, 0xffff5d00, v15
    ds_write_b128 v14, v[106:109] offset:0
    ds_write_b128 v14, v[110:113] offset:1024
    ds_write_b128 v15, v[114:117] offset:8192
    v_add_u32 v14, 0xd300, v14
    v_add_u32 v15, 0xd300, v15
    ds_write_b128 v14, v[130:133] offset:0
    ds_write_b128 v14, v[134:137] offset:1024
    ds_write_b128 v15, v[138:141] offset:8192
    ds_write_b128 v14, v[142:145] offset:12288
    ds_write_b128 v14, v[146:149] offset:13312
    ds_write_b128 v15, v[150:153] offset:20480
    v_add_u32 v14, 0xfffe0d00, v14
    v_add_u32 v15, 0xfffe0d00, v15
    ds_write_b128 v14, v[34:37] offset:0
    ds_write_b128 v14, v[38:41] offset:1024
    ds_write_b128 v15, v[42:45] offset:8192
    s_waitcnt vmcnt(12)
    ds_write_b128 v14, v[46:49] offset:12288
    ds_write_b128 v14, v[50:53] offset:13312
    ds_write_b128 v15, v[54:57] offset:20480
    s_waitcnt vmcnt(9)
    ds_write_b128 v14, v[58:61] offset:24576
    ds_write_b128 v14, v[62:65] offset:25600
    ds_write_b128 v15, v[66:69] offset:32768
    s_waitcnt vmcnt(6)
    ds_write_b128 v14, v[70:73] offset:36864
    ds_write_b128 v14, v[74:77] offset:37888
    ds_write_b128 v15, v[78:81] offset:45056
    s_waitcnt vmcnt(3)
    ds_write_b128 v14, v[82:85] offset:49152
    ds_write_b128 v14, v[86:89] offset:50176
    ds_write_b128 v15, v[90:93] offset:57344
    s_waitcnt vmcnt(0)
    v_add_u32 v14, 0xf000, v14
    v_add_u32 v15, 0xf000, v15
    ds_write_b128 v14, v[94:97] offset:0
    ds_write_b128 v14, v[98:101] offset:1024
    ds_write_b128 v15, v[102:105] offset:8192
    s_waitcnt vmcnt(12)
    v_mfma_f32_16x16x32_bf16 v[30:33], v[22:25], v[46:49], v[30:33]
    v_mfma_f32_16x16x32_bf16 v[30:33], v[22:25], v[50:53], v[30:33]
    v_mfma_f32_16x16x32_bf16 v[30:33], v[26:29], v[54:57], v[30:33]
    s_waitcnt vmcnt(9)
    v_mfma_f32_16x16x32_bf16 v[30:33], v[22:25], v[58:61], v[30:33]
    v_mfma_f32_16x16x32_bf16 v[30:33], v[22:25], v[62:65], v[30:33]
    v_mfma_f32_16x16x32_bf16 v[30:33], v[26:29], v[66:69], v[30:33]
    s_waitcnt vmcnt(6)
    v_mfma_f32_16x16x32_bf16 v[30:33], v[22:25], v[70:73], v[30:33]
    v_mfma_f32_16x16x32_bf16 v[30:33], v[22:25], v[74:77], v[30:33]
    v_mfma_f32_16x16x32_bf16 v[30:33], v[26:29], v[78:81], v[30:33]
    s_waitcnt vmcnt(3)
    v_mfma_f32_16x16x32_bf16 v[30:33], v[22:25], v[82:85], v[30:33]
    v_mfma_f32_16x16x32_bf16 v[30:33], v[22:25], v[86:89], v[30:33]
    v_mfma_f32_16x16x32_bf16 v[30:33], v[26:29], v[90:93], v[30:33]
    s_waitcnt vmcnt(0)
    v_mfma_f32_16x16x32_bf16 v[30:33], v[22:25], v[94:97], v[30:33]
    v_mfma_f32_16x16x32_bf16 v[30:33], v[22:25], v[98:101], v[30:33]
    v_mfma_f32_16x16x32_bf16 v[30:33], v[26:29], v[102:105], v[30:33]
    s_nop 7
    v_add_f32_dpp v30, v30, v30 row_ror:8 row_mask:0xf bank_mask:0xf
    v_add_f32_dpp v31, v31, v31 row_ror:8 row_mask:0xf bank_mask:0xf
    v_add_f32_dpp v32, v32, v32 row_ror:8 row_mask:0xf bank_mask:0xf
    v_add_f32_dpp v33, v33, v33 row_ror:8 row_mask:0xf bank_mask:0xf
    v_add_f32_dpp v30, v30, v30 row_ror:4 row_mask:0xc bank_mask:0xf
    v_add_f32_dpp v31, v31, v31 row_ror:4 row_mask:0xc bank_mask:0xf
    v_add_f32_dpp v32, v32, v32 row_ror:4 row_mask:0xc bank_mask:0xf
    v_add_f32_dpp v33, v33, v33 row_ror:4 row_mask:0xc bank_mask:0xf
    s_mov_b32 exec_lo, 0x00ff00ff
    s_mov_b32 exec_hi, 0x000f000f
    ds_write_b128 v17, v[30:33]
    s_mov_b64 exec, -1
    s_waitcnt lgkmcnt(0)
    s_barrier
    s_add_u32 s53, s82, 0
    s_sub_u32 s54, s53, 24
    s_cselect_b32 s53, s53, s54
    s_lshl_b32 s54, s53, 10
    s_mul_i32 s53, s53, 40960
    s_add_u32 s54, s54, s80
    s_add_u32 m0, s73, 94464
    s_nop 0
    buffer_load_dwordx4 v10, s[68:71], s53 offen offset:0 lds
    buffer_load_dwordx4 v11, s[68:71], s53 offen offset:1056 lds
    s_add_u32 m0, s74, 102912
    s_mov_b64 exec, s[66:67]
    buffer_load_dwordx4 v1, s[4:7], s54 offen sc1 lds
    s_mov_b64 exec, -1
    s_add_u32 s53, s82, 1
    s_sub_u32 s54, s53, 24
    s_cselect_b32 s53, s53, s54
    s_lshl_b32 s54, s53, 10
    s_mul_i32 s53, s53, 40960
    s_add_u32 s54, s54, s80
    s_add_u32 m0, s73, 104960
    s_nop 0
    buffer_load_dwordx4 v10, s[68:71], s53 offen offset:0 lds
    buffer_load_dwordx4 v11, s[68:71], s53 offen offset:1056 lds
    s_add_u32 m0, s74, 113408
    s_mov_b64 exec, s[66:67]
    buffer_load_dwordx4 v1, s[4:7], s54 offen sc1 lds
    s_mov_b64 exec, -1
    s_cmp_lg_u32 s52, 3
    s_cbranch_scc1 .lcs_15
    v_lshlrev_b32 v2, 3, v0
    v_add_u32 v2, 156800, v2
    ds_read_b64 v[34:35], v2 offset:0
    ds_read_b64 v[36:37], v2 offset:384
    ds_read_b64 v[38:39], v2 offset:768
    ds_read_b64 v[40:41], v2 offset:1152
    v_add_u32 v2, 161792, v1
    s_waitcnt lgkmcnt(0)
    v_pk_add_f32 v[34:35], v[34:35], v[36:37]
    v_pk_add_f32 v[38:39], v[38:39], v[40:41]
    v_pk_add_f32 v[34:35], v[34:35], v[38:39]
    v_cvt_pk_bf16_f32 v42, v34, v35
    v_lshlrev_b32 v36, 16, v42
    v_and_b32 v37, 0xffff0000, v42
    v_pk_add_f32 v[34:35], v[34:35], v[36:37] neg_lo:[0,1] neg_hi:[0,1]
    v_cvt_pk_bf16_f32 v43, v34, v35
    v_lshlrev_b32 v36, 16, v43
    v_and_b32 v37, 0xffff0000, v43
    v_pk_add_f32 v[34:35], v[34:35], v[36:37] neg_lo:[0,1] neg_hi:[0,1]
    v_cvt_pk_bf16_f32 v44, v34, v35
    s_mov_b32 s53, 0x05040100
    s_mov_b32 s54, 0x07060302
    v_perm_b32 v38, v43, v42, s53
    v_perm_b32 v39, v16, v44, s53
    v_perm_b32 v40, v43, v42, s54
    v_perm_b32 v41, v16, v44, s54
    s_mov_b32 exec_hi, 0xffff
    ds_write_b128 v2, v[38:41]
    s_mov_b64 exec, -1
    s_waitcnt lgkmcnt(0)
.lcs_15:
    s_barrier
    s_add_u32 s53, s82, 2
    s_sub_u32 s54, s53, 24
    s_cselect_b32 s53, s53, s54
    s_lshl_b32 s54, s53, 10
    s_mul_i32 s53, s53, 40960
    s_add_u32 s54, s54, s80
    s_add_u32 m0, s73, 0
    s_nop 0
    buffer_load_dwordx4 v10, s[68:71], s53 offen offset:0 lds
    buffer_load_dwordx4 v11, s[68:71], s53 offen offset:1056 lds
    s_add_u32 m0, s74, 8448
    s_mov_b64 exec, s[66:67]
    buffer_load_dwordx4 v1, s[4:7], s54 offen sc1 lds
    s_mov_b64 exec, -1
    s_add_u32 s53, s82, 3
    s_sub_u32 s54, s53, 24
    s_cselect_b32 s53, s53, s54
    s_lshl_b32 s54, s53, 10
    s_mul_i32 s53, s53, 40960
    s_add_u32 s54, s54, s80
    s_add_u32 m0, s73, 10496
    s_nop 0
    buffer_load_dwordx4 v10, s[68:71], s53 offen offset:0 lds
    buffer_load_dwordx4 v11, s[68:71], s53 offen offset:1056 lds
    s_add_u32 m0, s74, 18944
    s_mov_b64 exec, s[66:67]
    buffer_load_dwordx4 v1, s[4:7], s54 offen sc1 lds
    s_mov_b64 exec, -1
    s_add_u32 s53, s82, 4
    s_sub_u32 s54, s53, 24
    s_cselect_b32 s53, s53, s54
    s_lshl_b32 s54, s53, 10
    s_mul_i32 s53, s53, 40960
    s_add_u32 s54, s54, s80
    s_add_u32 m0, s73, 20992
    s_nop 0
    buffer_load_dwordx4 v10, s[68:71], s53 offen offset:0 lds
    buffer_load_dwordx4 v11, s[68:71], s53 offen offset:1056 lds
    s_add_u32 m0, s74, 29440
    s_mov_b64 exec, s[66:67]
    buffer_load_dwordx4 v1, s[4:7], s54 offen sc1 lds
    s_mov_b64 exec, -1
    s_add_u32 s53, s82, 5
    s_sub_u32 s54, s53, 24
    s_cselect_b32 s53, s53, s54
    s_lshl_b32 s54, s53, 10
    s_mul_i32 s53, s53, 40960
    s_add_u32 s54, s54, s80
    s_add_u32 m0, s73, 31488
    s_nop 0
    buffer_load_dwordx4 v10, s[68:71], s53 offen offset:0 lds
    buffer_load_dwordx4 v11, s[68:71], s53 offen offset:1056 lds
    s_add_u32 m0, s74, 39936
    s_mov_b64 exec, s[66:67]
    buffer_load_dwordx4 v1, s[4:7], s54 offen sc1 lds
    s_mov_b64 exec, -1
    s_barrier
    s_add_u32 s53, s82, 6
    s_sub_u32 s54, s53, 24
    s_cselect_b32 s53, s53, s54
    s_lshl_b32 s54, s53, 10
    s_mul_i32 s53, s53, 40960
    s_add_u32 s54, s54, s80
    s_add_u32 m0, s73, 41984
    s_nop 0
    buffer_load_dwordx4 v10, s[68:71], s53 offen offset:0 lds
    buffer_load_dwordx4 v11, s[68:71], s53 offen offset:1056 lds
    s_add_u32 m0, s74, 50432
    s_mov_b64 exec, s[66:67]
    buffer_load_dwordx4 v1, s[4:7], s54 offen sc1 lds
    s_mov_b64 exec, -1
    s_add_u32 s53, s82, 7
    s_sub_u32 s54, s53, 24
    s_cselect_b32 s53, s53, s54
    s_lshl_b32 s54, s53, 10
    s_mul_i32 s53, s53, 40960
    s_add_u32 s54, s54, s80
    s_add_u32 m0, s73, 52480
    s_nop 0
    buffer_load_dwordx4 v10, s[68:71], s53 offen offset:0 lds
    buffer_load_dwordx4 v11, s[68:71], s53 offen offset:1056 lds
    s_add_u32 m0, s74, 60928
    s_mov_b64 exec, s[66:67]
    buffer_load_dwordx4 v1, s[4:7], s54 offen sc1 lds
    s_mov_b64 exec, -1
    s_add_u32 s53, s82, 8
    s_sub_u32 s54, s53, 24
    s_cselect_b32 s53, s53, s54
    s_lshl_b32 s54, s53, 10
    s_mul_i32 s53, s53, 40960
    s_add_u32 s54, s54, s80
    s_add_u32 m0, s73, 62976
    s_nop 0
    buffer_load_dwordx4 v10, s[68:71], s53 offen offset:0 lds
    buffer_load_dwordx4 v11, s[68:71], s53 offen offset:1056 lds
    s_add_u32 m0, s74, 71424
    s_mov_b64 exec, s[66:67]
    buffer_load_dwordx4 v1, s[4:7], s54 offen sc1 lds
    s_mov_b64 exec, -1
    s_add_u32 s53, s82, 9
    s_sub_u32 s54, s53, 24
    s_cselect_b32 s53, s53, s54
    s_lshl_b32 s54, s53, 10
    s_mul_i32 s53, s53, 40960
    s_add_u32 s54, s54, s80
    s_add_u32 m0, s73, 73472
    s_nop 0
    buffer_load_dwordx4 v10, s[68:71], s53 offen offset:0 lds
    buffer_load_dwordx4 v11, s[68:71], s53 offen offset:1056 lds
    s_add_u32 m0, s74, 81920
    s_mov_b64 exec, s[66:67]
    buffer_load_dwordx4 v1, s[4:7], s54 offen sc1 lds
    s_mov_b64 exec, -1
    s_waitcnt vmcnt(21)
    s_barrier
    s_setprio 3
    s_add_u32 s53, s82, 10
    s_sub_u32 s54, s53, 24
    s_cselect_b32 s53, s53, s54
    s_lshl_b32 s54, s53, 10
    s_mul_i32 s53, s53, 40960
    s_add_u32 s54, s54, s80
    s_add_u32 m0, s73, 83968
    s_waitcnt vmcnt(3)
    buffer_load_dwordx4 v10, s[68:71], s53 offen offset:0 lds
    s_waitcnt vmcnt(3)
    buffer_load_dwordx4 v11, s[68:71], s53 offen offset:1056 lds
    s_add_u32 m0, s74, 92416
    s_mov_b64 exec, s[66:67]
    buffer_load_dwordx4 v1, s[4:7], s54 offen sc1 lds
    s_mov_b64 exec, -1
    s_add_u32 s53, s82, 11
    s_sub_u32 s54, s53, 24
    s_cselect_b32 s53, s53, s54
    s_lshl_b32 s54, s53, 10
    s_mul_i32 s53, s53, 40960
    s_add_u32 s54, s54, s80
    s_add_u32 m0, s73, 115456
    s_waitcnt vmcnt(3)
    buffer_load_dwordx4 v10, s[68:71], s53 offen offset:0 lds
    s_waitcnt vmcnt(3)
    buffer_load_dwordx4 v11, s[68:71], s53 offen offset:1056 lds
    s_add_u32 m0, s74, 123904
    s_mov_b64 exec, s[66:67]
    buffer_load_dwordx4 v1, s[4:7], s54 offen sc1 lds
    s_mov_b64 exec, -1
    s_add_u32 s53, s82, 12
    s_sub_u32 s54, s53, 24
    s_cselect_b32 s53, s53, s54
    s_lshl_b32 s54, s53, 10
    s_mul_i32 s53, s53, 40960
    s_add_u32 s54, s54, s80
    s_add_u32 m0, s73, 125952
    s_waitcnt vmcnt(3)
    buffer_load_dwordx4 v10, s[68:71], s53 offen offset:0 lds
    s_waitcnt vmcnt(3)
    buffer_load_dwordx4 v11, s[68:71], s53 offen offset:1056 lds
    s_add_u32 m0, s74, 134400
    s_mov_b64 exec, s[66:67]
    buffer_load_dwordx4 v1, s[4:7], s54 offen sc1 lds
    s_mov_b64 exec, -1
    s_add_u32 s53, s82, 13
    s_sub_u32 s54, s53, 24
    s_cselect_b32 s53, s53, s54
    s_lshl_b32 s54, s53, 10
    s_mul_i32 s53, s53, 40960
    s_add_u32 s54, s54, s80
    s_add_u32 m0, s73, 136448
    s_waitcnt vmcnt(3)
    buffer_load_dwordx4 v10, s[68:71], s53 offen offset:0 lds
    s_waitcnt vmcnt(3)
    buffer_load_dwordx4 v11, s[68:71], s53 offen offset:1056 lds
    s_add_u32 m0, s74, 144896
    s_mov_b64 exec, s[66:67]
    buffer_load_dwordx4 v1, s[4:7], s54 offen sc1 lds
    s_mov_b64 exec, -1
    s_add_u32 s53, s82, 14
    s_sub_u32 s54, s53, 24
    s_cselect_b32 s53, s53, s54
    s_lshl_b32 s54, s53, 10
    s_mul_i32 s53, s53, 40960
    s_add_u32 s54, s54, s80
    s_add_u32 m0, s73, 146944
    s_waitcnt vmcnt(3)
    buffer_load_dwordx4 v10, s[68:71], s53 offen offset:0 lds
    s_waitcnt vmcnt(3)
    buffer_load_dwordx4 v11, s[68:71], s53 offen offset:1056 lds
    s_add_u32 m0, s74, 155392
    s_mov_b64 exec, s[66:67]
    buffer_load_dwordx4 v1, s[4:7], s54 offen sc1 lds
    s_mov_b64 exec, -1
    s_waitcnt vmcnt(24)
    s_barrier
    s_waitcnt vmcnt(12)
    s_barrier
    s_add_u32 s53, s82, 18
    s_sub_u32 s54, s53, 24
    s_cselect_b32 s53, s53, s54
    s_lshl_b32 s54, s53, 10
    s_mul_i32 s53, s53, 40960
    s_add_u32 s54, s54, s80
    s_add_u32 m0, s73, 10496
    s_nop 0
    buffer_load_dwordx4 v10, s[68:71], s53 offen offset:0 lds
    buffer_load_dwordx4 v11, s[68:71], s53 offen offset:1056 lds
    s_add_u32 m0, s74, 18944
    s_mov_b64 exec, s[66:67]
    buffer_load_dwordx4 v1, s[4:7], s54 offen sc1 lds
    s_mov_b64 exec, -1
    s_add_u32 s53, s82, 19
    s_sub_u32 s54, s53, 24
    s_cselect_b32 s53, s53, s54
    s_lshl_b32 s54, s53, 10
    s_mul_i32 s53, s53, 40960
    s_add_u32 s54, s54, s80
    s_add_u32 m0, s73, 20992
    s_nop 0
    buffer_load_dwordx4 v10, s[68:71], s53 offen offset:0 lds
    buffer_load_dwordx4 v11, s[68:71], s53 offen offset:1056 lds
    s_add_u32 m0, s74, 29440
    s_mov_b64 exec, s[66:67]
    buffer_load_dwordx4 v1, s[4:7], s54 offen sc1 lds
    s_mov_b64 exec, -1
    s_add_u32 s53, s82, 20
    s_sub_u32 s54, s53, 24
    s_cselect_b32 s53, s53, s54
    s_lshl_b32 s54, s53, 10
    s_mul_i32 s53, s53, 40960
    s_add_u32 s54, s54, s80
    s_add_u32 m0, s73, 31488
    s_nop 0
    buffer_load_dwordx4 v10, s[68:71], s53 offen offset:0 lds
    buffer_load_dwordx4 v11, s[68:71], s53 offen offset:1056 lds
    s_add_u32 m0, s74, 39936
    s_mov_b64 exec, s[66:67]
    buffer_load_dwordx4 v1, s[4:7], s54 offen sc1 lds
    s_mov_b64 exec, -1
    s_waitcnt vmcnt(9)
    s_barrier
    s_add_u32 s53, s82, 21
    s_sub_u32 s54, s53, 24
    s_cselect_b32 s53, s53, s54
    s_lshl_b32 s54, s53, 10
    s_mul_i32 s53, s53, 40960
    s_add_u32 s54, s54, s80
    s_add_u32 m0, s73, 41984
    s_nop 0
    buffer_load_dwordx4 v10, s[68:71], s53 offen offset:0 lds
    buffer_load_dwordx4 v11, s[68:71], s53 offen offset:1056 lds
    s_add_u32 m0, s74, 50432
    s_mov_b64 exec, s[66:67]
    buffer_load_dwordx4 v1, s[4:7], s54 offen sc1 lds
    s_mov_b64 exec, -1
    s_add_u32 s53, s82, 22
    s_sub_u32 s54, s53, 24
    s_cselect_b32 s53, s53, s54
    s_lshl_b32 s54, s53, 10
    s_mul_i32 s53, s53, 40960
    s_add_u32 s54, s54, s80
    s_add_u32 m0, s73, 52480
    s_nop 0
    buffer_load_dwordx4 v10, s[68:71], s53 offen offset:0 lds
    buffer_load_dwordx4 v11, s[68:71], s53 offen offset:1056 lds
    s_add_u32 m0, s74, 60928
    s_mov_b64 exec, s[66:67]
    buffer_load_dwordx4 v1, s[4:7], s54 offen sc1 lds
    s_mov_b64 exec, -1
    s_add_u32 s53, s82, 23
    s_sub_u32 s54, s53, 24
    s_cselect_b32 s53, s53, s54
    s_lshl_b32 s54, s53, 10
    s_mul_i32 s53, s53, 40960
    s_add_u32 s54, s54, s80
    s_add_u32 m0, s73, 62976
    s_nop 0
    buffer_load_dwordx4 v10, s[68:71], s53 offen offset:0 lds
    buffer_load_dwordx4 v11, s[68:71], s53 offen offset:1056 lds
    s_add_u32 m0, s74, 71424
    s_mov_b64 exec, s[66:67]
    buffer_load_dwordx4 v1, s[4:7], s54 offen sc1 lds
    s_mov_b64 exec, -1
    s_waitcnt vmcnt(9)
    s_barrier
    s_waitcnt vmcnt(0)
    s_barrier
    s_or_b32 s53, s2, s52
    s_cmp_lg_u32 s53, 0
    s_cbranch_scc1 .lend_16
    s_mov_b32 s47, 65536
    s_mov_b32 s53, 29361152
.bp_17:
    buffer_load_dwordx4 v[34:37], v1, s[4:7], s53 offen sc1
    s_sub_u32 s47, s47, 1
    s_cbranch_scc1 .bd_18
    s_waitcnt vmcnt(0)
    v_xor_b32 v34, s45, v34
    v_xor_b32 v35, s45, v35
    v_xor_b32 v36, s45, v36
    v_xor_b32 v37, s45, v37
    v_or3_b32 v34, v34, v35, v36
    v_or_b32 v34, v34, v37
    v_cmp_lt_u32 vcc, 7, v34
    s_cmp_lg_u64 vcc, 0
    s_cbranch_scc1 .bp_17
.bd_18:
    v_mov_b32 v2, s45
    s_mov_b32 s53, 29360128
    s_mov_b64 exec, 1
    buffer_store_dword v2, off, s[4:7], s53 sc1
.lend_16:
    s_endpgm
.end_1:
    s_endpgm
.p2align 8
.compute_3:
    s_setprio 1
    v_and_b32 v14, 15, v0
    v_lshrrev_b32 v15, 4, v0
    v_lshrrev_b32 v16, 1, v14
    v_xor_b32 v17, v16, v15
    v_lshlrev_b32 v17, 4, v17
    v_lshl_add_u32 v17, v14, 7, v17
    v_add_u32 v134, 33792, v17
    v_xor_b32 v135, 64, v134
    v_lshrrev_b32 v17, 5, v0
    v_xor_b32 v16, v16, v17
    v_lshlrev_b32 v16, 4, v16
    v_lshl_add_u32 v16, v14, 7, v16
    v_and_b32 v141, 1, v15
    v_lshl_add_u32 v16, v141, 3, v16
    s_and_b32 s54, s38, 3
    s_lshl_b32 s52, s54, 11
    v_add_u32 v141, s52, v16
    v_lshlrev_b32 v16, 4, v17
    v_bfe_u32 v17, v0, 2, 3
    v_add_u32 v16, v16, v17
    v_mul_u32_u24 v16, 1056, v16
    v_and_b32 v17, 3, v0
    v_lshl_add_u32 v16, v17, 3, v16
    s_lshl_b32 s52, s38, 6
    v_add_u32 v136, s52, v16
    s_lshr_b32 s74, s44, 2
    s_add_u32 s73, s74, s44
    s_mul_i32 s74, s74, 5
    s_add_u32 s74, s74, 4
    s_add_u32 s52, s43, s44
    s_and_b32 s52, s52, 3
    s_mov_b32 s64, 0x87524310
    s_mov_b32 s65, 0x96
    s_cmp_eq_u32 s52, 1
    s_cselect_b32 s64, 0x74653120, s64
    s_cselect_b32 s65, 0x89, s65
    s_cmp_eq_u32 s52, 2
    s_cselect_b32 s64, 0x86354201, s64
    s_cselect_b32 s65, 0x79, s65
    s_cmp_eq_u32 s52, 3
    s_cselect_b32 s64, 0x57641302, s64
    s_cselect_b32 s65, 0x98, s65
    s_sub_u32 s52, s73, s39
    s_cselect_b32 s53, 10, 0
    s_add_u32 s52, s52, s53
    s_lshl_b32 s52, s52, 2
    s_lshr_b64 s[66:67], s[64:65], s52
    s_and_b32 s62, s66, 15
    s_sub_u32 s52, s74, s39
    s_cselect_b32 s53, 10, 0
    s_add_u32 s52, s52, s53
    s_lshl_b32 s52, s52, 2
    s_lshr_b64 s[66:67], s[64:65], s52
    s_and_b32 s63, s66, 15
    s_and_b32 s57, s44, 3
    s_lshl_b32 s57, s57, 5
    s_cmp_lg_u32 s38, 1
    s_cbranch_scc1 .n1_20
    v_mov_b32 v140, 0x3f803f80
    v_and_b32 v16, 31, v0
    v_lshlrev_b32 v16, 2, v16
    v_add_u32 v17, 44032, v16
    ds_write_b32 v16, v140 offset:41984
    ds_write_b32 v17, v140 offset:41984
    v_add_u32 v17, 88064, v16
    ds_write_b32 v17, v140 offset:41984
.n1_20:
    s_mov_b32 s4, s36
    s_and_b32 s5, s37, 0xffff
    s_mov_b32 s6, 33554432
    s_mov_b32 s7, 0x00020000
    s_cmp_lg_u32 s38, 2
    s_cbranch_scc1 .ef_21
    v_lshrrev_b32 v140, 2, v0
    v_lshlrev_b32 v140, 7, v140
    v_and_or_b32 v140, v0, 3, v140
    v_lshlrev_b32 v140, 7, v140
    s_lshl_b32 s52, s41, 9
    s_add_u32 s52, s52, 29376512
    s_mov_b64 exec, 0xfff
    buffer_load_dword v140, v140, s[4:7], s52 offen sc1
    s_mov_b64 exec, -1
.ef_21:
    s_waitcnt lgkmcnt(0)
    s_barrier
    ds_read_b64_tr_b16 v[106:107], v136 offset:0
    ds_read_b64_tr_b16 v[108:109], v136 offset:8448
    ds_read_b64_tr_b16 v[110:111], v136 offset:32
    ds_read_b64_tr_b16 v[112:113], v136 offset:8480
    ds_read_b128 v[66:69], v134 offset:0
    ds_read_b128 v[70:73], v134 offset:2048
    ds_read_b128 v[74:77], v134 offset:4096
    ds_read_b128 v[78:81], v134 offset:6144
    ds_read_b128 v[82:85], v134 offset:8192
    s_cmp_eq_u32 s62, 0
    s_cbranch_scc1 .cap_22
.capb_23:
    s_cmp_eq_u32 s63, 0
    s_cbranch_scc1 .cap_24
.capb_25:
    s_waitcnt lgkmcnt(0)
    v_mfma_f32_16x16x32_bf16 v[26:29], v[106:109], v[66:69], 0
    ds_read_b64_tr_b16 v[114:115], v136 offset:512
    ds_read_b64_tr_b16 v[116:117], v136 offset:8960
    v_mfma_f32_16x16x32_bf16 v[46:49], v[110:113], v[66:69], 0
    ds_read_b64_tr_b16 v[118:119], v136 offset:544
    ds_read_b64_tr_b16 v[120:121], v136 offset:8992
    v_mfma_f32_16x16x32_bf16 v[30:33], v[106:109], v[70:73], 0
    ds_read_b128 v[86:89], v135 offset:0
    ds_read_b128 v[90:93], v135 offset:2048
    v_mfma_f32_16x16x32_bf16 v[50:53], v[110:113], v[70:73], 0
    ds_read_b128 v[94:97], v135 offset:4096
    ds_read_b128 v[98:101], v135 offset:6144
    v_mfma_f32_16x16x32_bf16 v[34:37], v[106:109], v[74:77], 0
    ds_read_b128 v[102:105], v135 offset:8192
    v_mfma_f32_16x16x32_bf16 v[54:57], v[110:113], v[74:77], 0
    v_mfma_f32_16x16x32_bf16 v[38:41], v[106:109], v[78:81], 0
    v_mfma_f32_16x16x32_bf16 v[58:61], v[110:113], v[78:81], 0
    v_mfma_f32_16x16x32_bf16 v[42:45], v[106:109], v[82:85], 0
    v_mfma_f32_16x16x32_bf16 v[62:65], v[110:113], v[82:85], 0
    v_add_u32 v134, 0xac00, v134
    v_add_u32 v136, 0xac00, v136
    v_add_u32 v135, 0xac00, v135
    s_and_b32 s45, s45, 0xfffffff8
    s_add_u32 s45, s45, 8
    s_mov_b32 s34, s45
    s_mov_b32 s35, s45
    s_cmp_lg_u32 s38, 0
    s_cbranch_scc1 .hello_26
    s_getreg_b32 s47, hwreg(HW_REG_XCC_ID, 0, 3)
    s_or_b32 s47, s47, s45
    v_mov_b32 v137, s47
    s_lshl4_add_u32 s47, s41, s42
    s_lshl_b32 s47, s47, 2
    s_add_u32 s47, s47, 29361152
    s_mov_b64 exec, 1
    buffer_store_dword v137, off, s[4:7], s47 sc1
    s_mov_b64 exec, -1
.hello_26:
    s_waitcnt lgkmcnt(0)
    s_barrier
    ds_read_b64_tr_b16 v[106:107], v136 offset:0
    ds_read_b64_tr_b16 v[108:109], v136 offset:8448
    v_mfma_f32_16x16x32_bf16 v[26:29], v[114:117], v[86:89], v[26:29]
    ds_read_b64_tr_b16 v[110:111], v136 offset:32
    ds_read_b64_tr_b16 v[112:113], v136 offset:8480
    v_mfma_f32_16x16x32_bf16 v[46:49], v[118:121], v[86:89], v[46:49]
    ds_read_b128 v[66:69], v134 offset:0
    ds_read_b128 v[70:73], v134 offset:2048
    v_mfma_f32_16x16x32_bf16 v[30:33], v[114:117], v[90:93], v[30:33]
    ds_read_b128 v[74:77], v134 offset:4096
    ds_read_b128 v[78:81], v134 offset:6144
    v_mfma_f32_16x16x32_bf16 v[50:53], v[118:121], v[90:93], v[50:53]
    ds_read_b128 v[82:85], v134 offset:8192
    v_mfma_f32_16x16x32_bf16 v[34:37], v[114:117], v[94:97], v[34:37]
    v_mfma_f32_16x16x32_bf16 v[54:57], v[118:121], v[94:97], v[54:57]
    v_mfma_f32_16x16x32_bf16 v[38:41], v[114:117], v[98:101], v[38:41]
    v_mfma_f32_16x16x32_bf16 v[58:61], v[118:121], v[98:101], v[58:61]
    v_mfma_f32_16x16x32_bf16 v[42:45], v[114:117], v[102:105], v[42:45]
    v_mfma_f32_16x16x32_bf16 v[62:65], v[118:121], v[102:105], v[62:65]
    s_cmp_eq_u32 s62, 1
    s_cbranch_scc1 .cap_27
.capb_28:
    s_cmp_eq_u32 s63, 1
    s_cbranch_scc1 .cap_29
.capb_30:
    s_waitcnt lgkmcnt(0)
    v_mfma_f32_16x16x32_bf16 v[26:29], v[106:109], v[66:69], v[26:29]
    ds_read_b64_tr_b16 v[114:115], v136 offset:512
    ds_read_b64_tr_b16 v[116:117], v136 offset:8960
    v_mfma_f32_16x16x32_bf16 v[46:49], v[110:113], v[66:69], v[46:49]
    ds_read_b64_tr_b16 v[118:119], v136 offset:544
    ds_read_b64_tr_b16 v[120:121], v136 offset:8992
    v_mfma_f32_16x16x32_bf16 v[30:33], v[106:109], v[70:73], v[30:33]
    ds_read_b128 v[86:89], v135 offset:0
    ds_read_b128 v[90:93], v135 offset:2048
    v_mfma_f32_16x16x32_bf16 v[50:53], v[110:113], v[70:73], v[50:53]
    ds_read_b128 v[94:97], v135 offset:4096
    ds_read_b128 v[98:101], v135 offset:6144
    v_mfma_f32_16x16x32_bf16 v[34:37], v[106:109], v[74:77], v[34:37]
    ds_read_b128 v[102:105], v135 offset:8192
    v_mfma_f32_16x16x32_bf16 v[54:57], v[110:113], v[74:77], v[54:57]
    v_mfma_f32_16x16x32_bf16 v[38:41], v[106:109], v[78:81], v[38:41]
    v_mfma_f32_16x16x32_bf16 v[58:61], v[110:113], v[78:81], v[58:61]
    v_mfma_f32_16x16x32_bf16 v[42:45], v[106:109], v[82:85], v[42:45]
    v_mfma_f32_16x16x32_bf16 v[62:65], v[110:113], v[82:85], v[62:65]
    v_add_u32 v134, 0xac00, v134
    v_add_u32 v136, 0xac00, v136
    v_add_u32 v135, 0xac00, v135
    v_lshlrev_b32 v1, 4, v0
    s_mov_b32 s12, s32
    s_and_b32 s13, s33, 0xffff
    s_mov_b32 s14, 2621440
    s_mov_b32 s15, 0x00020000
    v_lshlrev_b32 v139, 3, v14
    v_add_u32 v139, 160896, v139
    v_mul_u32_u24 v16, 488, v14
    v_lshl_add_u32 v16, v15, 3, v16
    s_lshl_b32 s52, s38, 6
    s_add_u32 s52, s52, 88064
    v_add_u32 v138, s52, v16
    s_lshr_b32 s55, s38, 2
    s_lshl_b32 s58, s54, 4
    s_sub_u32 s59, s58, 16
    s_lshl_b32 s52, s54, 2
    s_add_u32 s52, s52, 56
    s_bitcmp1_b32 s54, 0
    s_cselect_b32 s59, s59, s52
    s_mul_i32 s52, s55, 80
    s_add_u32 s52, s52, 88064
    s_mul_i32 s58, s58, 488
    s_mul_i32 s59, s59, 488
    s_add_u32 s58, s58, s52
    s_add_u32 s59, s59, s52
    v_add_u32 v142, s58, v16
    s_waitcnt lgkmcnt(0)
    s_barrier
    ds_read_b64_tr_b16 v[106:107], v136 offset:0
    ds_read_b64_tr_b16 v[108:109], v136 offset:8448
    v_mfma_f32_16x16x32_bf16 v[26:29], v[114:117], v[86:89], v[26:29]
    ds_read_b64_tr_b16 v[110:111], v136 offset:32
    ds_read_b64_tr_b16 v[112:113], v136 offset:8480
    v_mfma_f32_16x16x32_bf16 v[46:49], v[118:121], v[86:89], v[46:49]
    ds_read_b128 v[66:69], v134 offset:0
    ds_read_b128 v[70:73], v134 offset:2048
    v_mfma_f32_16x16x32_bf16 v[30:33], v[114:117], v[90:93], v[30:33]
    ds_read_b128 v[74:77], v134 offset:4096
    ds_read_b128 v[78:81], v134 offset:6144
    v_mfma_f32_16x16x32_bf16 v[50:53], v[118:121], v[90:93], v[50:53]
    ds_read_b128 v[82:85], v134 offset:8192
    v_mfma_f32_16x16x32_bf16 v[34:37], v[114:117], v[94:97], v[34:37]
    v_mfma_f32_16x16x32_bf16 v[54:57], v[118:121], v[94:97], v[54:57]
    v_mfma_f32_16x16x32_bf16 v[38:41], v[114:117], v[98:101], v[38:41]
    v_mfma_f32_16x16x32_bf16 v[58:61], v[118:121], v[98:101], v[58:61]
    v_mfma_f32_16x16x32_bf16 v[42:45], v[114:117], v[102:105], v[42:45]
    v_mfma_f32_16x16x32_bf16 v[62:65], v[118:121], v[102:105], v[62:65]
    s_cmp_eq_u32 s62, 2
    s_cbranch_scc1 .cap_31
.capb_32:
    s_cmp_eq_u32 s63, 2
    s_cbranch_scc1 .cap_33
.capb_34:
    s_waitcnt lgkmcnt(0)
    v_mfma_f32_16x16x32_bf16 v[26:29], v[106:109], v[66:69], v[26:29]
    ds_read_b64_tr_b16 v[114:115], v136 offset:512
    ds_read_b64_tr_b16 v[116:117], v136 offset:8960
    v_mfma_f32_16x16x32_bf16 v[46:49], v[110:113], v[66:69], v[46:49]
    ds_read_b64_tr_b16 v[118:119], v136 offset:544
    ds_read_b64_tr_b16 v[120:121], v136 offset:8992
    v_mfma_f32_16x16x32_bf16 v[30:33], v[106:109], v[70:73], v[30:33]
    ds_read_b128 v[86:89], v135 offset:0
    ds_read_b128 v[90:93], v135 offset:2048
    v_mfma_f32_16x16x32_bf16 v[50:53], v[110:113], v[70:73], v[50:53]
    ds_read_b128 v[94:97], v135 offset:4096
    ds_read_b128 v[98:101], v135 offset:6144
    v_mfma_f32_16x16x32_bf16 v[34:37], v[106:109], v[74:77], v[34:37]
    ds_read_b128 v[102:105], v135 offset:8192
    v_mfma_f32_16x16x32_bf16 v[54:57], v[110:113], v[74:77], v[54:57]
    v_mfma_f32_16x16x32_bf16 v[38:41], v[106:109], v[78:81], v[38:41]
    v_mfma_f32_16x16x32_bf16 v[58:61], v[110:113], v[78:81], v[58:61]
    v_mfma_f32_16x16x32_bf16 v[42:45], v[106:109], v[82:85], v[42:45]
    v_mfma_f32_16x16x32_bf16 v[62:65], v[110:113], v[82:85], v[62:65]
    v_add_u32 v134, 0xfffea800, v134
    v_add_u32 v136, 0xfffea800, v136
    v_add_u32 v135, 0xfffea800, v135
    s_waitcnt vmcnt(0)
    v_add_u32 v143, s59, v16
    v_lshrrev_b32 v16, 2, v0
    v_mul_u32_u24 v16, 488, v16
    v_add_u32 v146, s58, v16
    v_add_u32 v147, s59, v16
    v_and_b32 v16, 3, v0
    v_lshl_add_u32 v144, v16, 3, v146
    v_lshl_add_u32 v145, v16, 3, v147
    v_cmp_eq_u32 s[88:89], 1, v16
    v_cmp_eq_u32 s[90:91], 2, v16
    v_cmp_eq_u32 s[92:93], 3, v16
    v_bfe_u32 v16, v0, 4, 1
    v_lshrrev_b32 v17, 5, v0
    v_and_b32 v18, 0xf0, v1
    v_lshl_add_u32 v19, v17, 8, v18
    v_lshl_add_u32 v19, v16, 3, v19
    v_lshl_add_u32 v17, v16, 1, v17
    v_lshl_add_u32 v18, v17, 8, v18
    v_bfe_u32 v16, v0, 2, 3
    v_mul_u32_u24 v20, 1056, v16
    v_lshrrev_b32 v16, 5, v0
    v_lshl_add_u32 v20, v16, 7, v20
    v_and_b32 v16, 3, v0
    v_lshl_add_u32 v20, v16, 3, v20
    s_and_b32 s53, s38, 1
    s_lshl_b32 s52, s53, 9
    s_add_u32 s52, s52, 44032
    s_waitcnt lgkmcnt(0)
    s_barrier
    ds_read_b64_tr_b16 v[106:107], v136 offset:0
    ds_read_b64_tr_b16 v[108:109], v136 offset:8448
    v_mfma_f32_16x16x32_bf16 v[26:29], v[114:117], v[86:89], v[26:29]
    ds_read_b64_tr_b16 v[110:111], v136 offset:32
    ds_read_b64_tr_b16 v[112:113], v136 offset:8480
    v_mfma_f32_16x16x32_bf16 v[46:49], v[118:121], v[86:89], v[46:49]
    ds_read_b128 v[66:69], v134 offset:0
    ds_read_b128 v[70:73], v134 offset:2048
    v_mfma_f32_16x16x32_bf16 v[30:33], v[114:117], v[90:93], v[30:33]
    ds_read_b128 v[74:77], v134 offset:4096
    ds_read_b128 v[78:81], v134 offset:6144
    v_mfma_f32_16x16x32_bf16 v[50:53], v[118:121], v[90:93], v[50:53]
    ds_read_b128 v[82:85], v134 offset:8192
    v_mfma_f32_16x16x32_bf16 v[34:37], v[114:117], v[94:97], v[34:37]
    v_mfma_f32_16x16x32_bf16 v[54:57], v[118:121], v[94:97], v[54:57]
    v_mfma_f32_16x16x32_bf16 v[38:41], v[114:117], v[98:101], v[38:41]
    v_mfma_f32_16x16x32_bf16 v[58:61], v[118:121], v[98:101], v[58:61]
    v_mfma_f32_16x16x32_bf16 v[42:45], v[114:117], v[102:105], v[42:45]
    v_mfma_f32_16x16x32_bf16 v[62:65], v[118:121], v[102:105], v[62:65]
    s_cmp_eq_u32 s62, 3
    s_cbranch_scc1 .cap_35
.capb_36:
    s_cmp_eq_u32 s63, 3
    s_cbranch_scc1 .cap_37
.capb_38:
    s_waitcnt lgkmcnt(0)
    v_mfma_f32_16x16x32_bf16 v[26:29], v[106:109], v[66:69], v[26:29]
    ds_read_b64_tr_b16 v[114:115], v136 offset:512
    ds_read_b64_tr_b16 v[116:117], v136 offset:8960
    v_mfma_f32_16x16x32_bf16 v[46:49], v[110:113], v[66:69], v[46:49]
    ds_read_b64_tr_b16 v[118:119], v136 offset:544
    ds_read_b64_tr_b16 v[120:121], v136 offset:8992
    v_mfma_f32_16x16x32_bf16 v[30:33], v[106:109], v[70:73], v[30:33]
    ds_read_b128 v[86:89], v135 offset:0
    ds_read_b128 v[90:93], v135 offset:2048
    v_mfma_f32_16x16x32_bf16 v[50:53], v[110:113], v[70:73], v[50:53]
    ds_read_b128 v[94:97], v135 offset:4096
    ds_read_b128 v[98:101], v135 offset:6144
    v_mfma_f32_16x16x32_bf16 v[34:37], v[106:109], v[74:77], v[34:37]
    ds_read_b128 v[102:105], v135 offset:8192
    v_mfma_f32_16x16x32_bf16 v[54:57], v[110:113], v[74:77], v[54:57]
    v_mfma_f32_16x16x32_bf16 v[38:41], v[106:109], v[78:81], v[38:41]
    v_mfma_f32_16x16x32_bf16 v[58:61], v[110:113], v[78:81], v[58:61]
    v_mfma_f32_16x16x32_bf16 v[42:45], v[106:109], v[82:85], v[42:45]
    v_mfma_f32_16x16x32_bf16 v[62:65], v[110:113], v[82:85], v[62:65]
    v_add_u32 v134, 0xac00, v134
    v_add_u32 v136, 0xac00, v136
    v_add_u32 v135, 0xac00, v135
    v_add_u32 v20, s52, v20
    s_lshl_b32 s52, s53, 10
    s_add_u32 s52, s52, 44032
    v_add_u32 v21, s52, v1
    s_mul_i32 s52, s53, 20480
    v_add_u32 v24, s52, v1
    s_sub_u32 s52, 20480, s52
    v_add_u32 v25, s52, v1
    s_mul_i32 s52, s54, 5120
    s_add_u32 s52, s52, 94464
    v_add_u32 v23, s52, v1
    v_lshlrev_b32 v22, 2, v14
    v_mov_b32 v12, 0
    v_mov_b32 v13, 0
    s_and_b32 s52, s54, 1
    s_or_b32 s52, s52, s43
    s_cmp_eq_u32 s52, 0
    s_cselect_b32 s52, 100, 9
    v_lshlrev_b32 v15, 2, v15
    v_sub_u32 v15, v15, v14
    v_mov_b32 v17, 0xf149f2ca
    v_add_u32 v16, 7, v15
    v_cmp_ge_u32 vcc, 7, v16
    s_nop 1
    v_cndmask_b32 v122, v17, 0, vcc
    v_add_u32 v16, 0, v15
    v_cmp_le_i32 vcc, s52, v16
    s_nop 1
    v_cndmask_b32 v126, v17, 0, vcc
    s_waitcnt lgkmcnt(0)
    s_barrier
    ds_read_b64_tr_b16 v[106:107], v136 offset:0
    ds_read_b64_tr_b16 v[108:109], v136 offset:8448
    v_mfma_f32_16x16x32_bf16 v[26:29], v[114:117], v[86:89], v[26:29]
    ds_read_b64_tr_b16 v[110:111], v136 offset:32
    ds_read_b64_tr_b16 v[112:113], v136 offset:8480
    v_mfma_f32_16x16x32_bf16 v[46:49], v[118:121], v[86:89], v[46:49]
    ds_read_b128 v[66:69], v134 offset:0
    ds_read_b128 v[70:73], v134 offset:2048
    v_mfma_f32_16x16x32_bf16 v[30:33], v[114:117], v[90:93], v[30:33]
    ds_read_b128 v[74:77], v134 offset:4096
    ds_read_b128 v[78:81], v134 offset:6144
    v_mfma_f32_16x16x32_bf16 v[50:53], v[118:121], v[90:93], v[50:53]
    ds_read_b128 v[82:85], v134 offset:8192
    v_mfma_f32_16x16x32_bf16 v[34:37], v[114:117], v[94:97], v[34:37]
    v_mfma_f32_16x16x32_bf16 v[54:57], v[118:121], v[94:97], v[54:57]
    v_mfma_f32_16x16x32_bf16 v[38:41], v[114:117], v[98:101], v[38:41]
    v_mfma_f32_16x16x32_bf16 v[58:61], v[118:121], v[98:101], v[58:61]
    v_mfma_f32_16x16x32_bf16 v[42:45], v[114:117], v[102:105], v[42:45]
    v_mfma_f32_16x16x32_bf16 v[62:65], v[118:121], v[102:105], v[62:65]
    s_cmp_eq_u32 s62, 4
    s_cbranch_scc1 .cap_39
.capb_40:
    s_cmp_eq_u32 s63, 4
    s_cbranch_scc1 .cap_41
.capb_42:
    s_waitcnt lgkmcnt(0)
    v_mfma_f32_16x16x32_bf16 v[26:29], v[106:109], v[66:69], v[26:29]
    ds_read_b64_tr_b16 v[114:115], v136 offset:512
    ds_read_b64_tr_b16 v[116:117], v136 offset:8960
    v_mfma_f32_16x16x32_bf16 v[46:49], v[110:113], v[66:69], v[46:49]
    ds_read_b64_tr_b16 v[118:119], v136 offset:544
    ds_read_b64_tr_b16 v[120:121], v136 offset:8992
    v_mfma_f32_16x16x32_bf16 v[30:33], v[106:109], v[70:73], v[30:33]
    ds_read_b128 v[86:89], v135 offset:0
    ds_read_b128 v[90:93], v135 offset:2048
    v_mfma_f32_16x16x32_bf16 v[50:53], v[110:113], v[70:73], v[50:53]
    ds_read_b128 v[94:97], v135 offset:4096
    ds_read_b128 v[98:101], v135 offset:6144
    v_mfma_f32_16x16x32_bf16 v[34:37], v[106:109], v[74:77], v[34:37]
    ds_read_b128 v[102:105], v135 offset:8192
    v_mfma_f32_16x16x32_bf16 v[54:57], v[110:113], v[74:77], v[54:57]
    v_mfma_f32_16x16x32_bf16 v[38:41], v[106:109], v[78:81], v[38:41]
    v_mfma_f32_16x16x32_bf16 v[58:61], v[110:113], v[78:81], v[58:61]
    v_mfma_f32_16x16x32_bf16 v[42:45], v[106:109], v[82:85], v[42:45]
    v_mfma_f32_16x16x32_bf16 v[62:65], v[110:113], v[82:85], v[62:65]
    v_add_u32 v134, 0xac00, v134
    v_add_u32 v136, 0xac00, v136
    v_add_u32 v135, 0xac00, v135
    v_cmp_ge_i32 vcc, 0, v16
    v_mov_b32 v137, 0xffff
    s_nop 0
    v_cndmask_b32 v130, 0, v137, vcc
    v_add_u32 v16, 8, v15
    v_cmp_ge_u32 vcc, 7, v16
    s_nop 1
    v_cndmask_b32 v123, v17, 0, vcc
    v_add_u32 v16, 1, v15
    v_cmp_le_i32 vcc, s52, v16
    s_nop 1
    v_cndmask_b32 v127, v17, 0, vcc
    v_cmp_ge_i32 vcc, 0, v16
    v_mov_b32 v137, 0xffff0000
    s_nop 0
    v_cndmask_b32 v137, 0, v137, vcc
    v_or_b32 v130, v130, v137
    v_add_u32 v16, 9, v15
    v_cmp_ge_u32 vcc, 7, v16
    s_nop 1
    v_cndmask_b32 v124, v17, 0, vcc
    v_add_u32 v16, 2, v15
    v_cmp_le_i32 vcc, s52, v16
    s_nop 1
    v_cndmask_b32 v128, v17, 0, vcc
    v_cmp_ge_i32 vcc, 0, v16
    v_mov_b32 v137, 0xffff
    s_nop 0
    v_cndmask_b32 v131, 0, v137, vcc
    v_add_u32 v16, 10, v15
    v_cmp_ge_u32 vcc, 7, v16
    s_nop 1
    v_cndmask_b32 v125, v17, 0, vcc
    v_add_u32 v16, 3, v15
    v_cmp_le_i32 vcc, s52, v16
    s_waitcnt lgkmcnt(0)
    s_barrier
    ds_read_b64_tr_b16 v[106:107], v136 offset:0
    ds_read_b64_tr_b16 v[108:109], v136 offset:8448
    v_mfma_f32_16x16x32_bf16 v[26:29], v[114:117], v[86:89], v[26:29]
    ds_read_b64_tr_b16 v[110:111], v136 offset:32
    ds_read_b64_tr_b16 v[112:113], v136 offset:8480
    v_mfma_f32_16x16x32_bf16 v[46:49], v[118:121], v[86:89], v[46:49]
    ds_read_b128 v[66:69], v134 offset:0
    ds_read_b128 v[70:73], v134 offset:2048
    v_mfma_f32_16x16x32_bf16 v[30:33], v[114:117], v[90:93], v[30:33]
    ds_read_b128 v[74:77], v134 offset:4096
    ds_read_b128 v[78:81], v134 offset:6144
    v_mfma_f32_16x16x32_bf16 v[50:53], v[118:121], v[90:93], v[50:53]
    ds_read_b128 v[82:85], v134 offset:8192
    v_mfma_f32_16x16x32_bf16 v[34:37], v[114:117], v[94:97], v[34:37]
    v_mfma_f32_16x16x32_bf16 v[54:57], v[118:121], v[94:97], v[54:57]
    v_mfma_f32_16x16x32_bf16 v[38:41], v[114:117], v[98:101], v[38:41]
    v_mfma_f32_16x16x32_bf16 v[58:61], v[118:121], v[98:101], v[58:61]
    v_mfma_f32_16x16x32_bf16 v[42:45], v[114:117], v[102:105], v[42:45]
    v_mfma_f32_16x16x32_bf16 v[62:65], v[118:121], v[102:105], v[62:65]
    s_cmp_eq_u32 s62, 5
    s_cbranch_scc1 .cap_43
.capb_44:
    s_cmp_eq_u32 s63, 5
    s_cbranch_scc1 .cap_45
.capb_46:
    s_waitcnt lgkmcnt(0)
    v_mfma_f32_16x16x32_bf16 v[26:29], v[106:109], v[66:69], v[26:29]
    ds_read_b64_tr_b16 v[114:115], v136 offset:512
    ds_read_b64_tr_b16 v[116:117], v136 offset:8960
    v_mfma_f32_16x16x32_bf16 v[46:49], v[110:113], v[66:69], v[46:49]
    ds_read_b64_tr_b16 v[118:119], v136 offset:544
    ds_read_b64_tr_b16 v[120:121], v136 offset:8992
    v_mfma_f32_16x16x32_bf16 v[30:33], v[106:109], v[70:73], v[30:33]
    ds_read_b128 v[86:89], v135 offset:0
    ds_read_b128 v[90:93], v135 offset:2048
    v_mfma_f32_16x16x32_bf16 v[50:53], v[110:113], v[70:73], v[50:53]
    ds_read_b128 v[94:97], v135 offset:4096
    ds_read_b128 v[98:101], v135 offset:6144
    v_mfma_f32_16x16x32_bf16 v[34:37], v[106:109], v[74:77], v[34:37]
    ds_read_b128 v[102:105], v135 offset:8192
    v_mfma_f32_16x16x32_bf16 v[54:57], v[110:113], v[74:77], v[54:57]
    v_mfma_f32_16x16x32_bf16 v[38:41], v[106:109], v[78:81], v[38:41]
    v_mfma_f32_16x16x32_bf16 v[58:61], v[110:113], v[78:81], v[58:61]
    v_mfma_f32_16x16x32_bf16 v[42:45], v[106:109], v[82:85], v[42:45]
    v_mfma_f32_16x16x32_bf16 v[62:65], v[110:113], v[82:85], v[62:65]
    v_add_u32 v134, 0xfffea800, v134
    v_add_u32 v136, 0xfffea800, v136
    v_add_u32 v135, 0xfffea800, v135
    v_cndmask_b32 v129, v17, 0, vcc
    v_cmp_ge_i32 vcc, 0, v16
    v_mov_b32 v137, 0xffff0000
    s_nop 0
    v_cndmask_b32 v137, 0, v137, vcc
    v_or_b32 v131, v131, v137
    v_not_b32 v132, v130
    v_not_b32 v133, v131
    v_cmp_gt_u32 vcc, 16, v0
    s_nop 1
    v_cndmask_b32 v137, 0, -1, vcc
    s_mov_b32 s66, 0x3ea52b5c
    s_mov_b32 s67, 0x3ea52b5c
    s_lshl2_add_u32 s56, s43, s54
    s_mul_i32 s76, s56, 20480
    s_lshl1_add_u32 s53, s44, s55
    s_lshr_b32 s52, s53, 3
    s_lshl1_add_u32 s58, s52, s53
    s_lshl_b32 s58, s58, 10
    s_add_u32 s58, s58, s76
    s_lshl3_add_u32 s60, s52, s53
    s_mul_i32 s59, s52, 10
    s_bfe_u32 s52, s53, 0x10002
    s_add_u32 s59, s59, s52
    s_add_u32 s59, s59, 8
    s_lshl_b32 s59, s59, 10
    s_add_u32 s59, s59, s76
    s_and_b32 s52, s53, 3
    s_lshl_b32 s52, s52, 4
    s_waitcnt lgkmcnt(0)
    s_barrier
    ds_read_b64_tr_b16 v[106:107], v136 offset:0
    ds_read_b64_tr_b16 v[108:109], v136 offset:8448
    v_mfma_f32_16x16x32_bf16 v[26:29], v[114:117], v[86:89], v[26:29]
    ds_read_b64_tr_b16 v[110:111], v136 offset:32
    ds_read_b64_tr_b16 v[112:113], v136 offset:8480
    v_mfma_f32_16x16x32_bf16 v[46:49], v[118:121], v[86:89], v[46:49]
    ds_read_b128 v[66:69], v134 offset:0
    ds_read_b128 v[70:73], v134 offset:2048
    v_mfma_f32_16x16x32_bf16 v[30:33], v[114:117], v[90:93], v[30:33]
    ds_read_b128 v[74:77], v134 offset:4096
    ds_read_b128 v[78:81], v134 offset:6144
    v_mfma_f32_16x16x32_bf16 v[50:53], v[118:121], v[90:93], v[50:53]
    ds_read_b128 v[82:85], v134 offset:8192
    v_mfma_f32_16x16x32_bf16 v[34:37], v[114:117], v[94:97], v[34:37]
    v_mfma_f32_16x16x32_bf16 v[54:57], v[118:121], v[94:97], v[54:57]
    v_mfma_f32_16x16x32_bf16 v[38:41], v[114:117], v[98:101], v[38:41]
    v_mfma_f32_16x16x32_bf16 v[58:61], v[118:121], v[98:101], v[58:61]
    v_mfma_f32_16x16x32_bf16 v[42:45], v[114:117], v[102:105], v[42:45]
    v_mfma_f32_16x16x32_bf16 v[62:65], v[118:121], v[102:105], v[62:65]
    s_cmp_eq_u32 s62, 6
    s_cbranch_scc1 .cap_47
.capb_48:
    s_cmp_eq_u32 s63, 6
    s_cbranch_scc1 .cap_49
.capb_50:
    s_waitcnt lgkmcnt(0)
    v_mfma_f32_16x16x32_bf16 v[26:29], v[106:109], v[66:69], v[26:29]
    ds_read_b64_tr_b16 v[114:115], v136 offset:512
    ds_read_b64_tr_b16 v[116:117], v136 offset:8960
    v_mfma_f32_16x16x32_bf16 v[46:49], v[110:113], v[66:69], v[46:49]
    ds_read_b64_tr_b16 v[118:119], v136 offset:544
    ds_read_b64_tr_b16 v[120:121], v136 offset:8992
    v_mfma_f32_16x16x32_bf16 v[30:33], v[106:109], v[70:73], v[30:33]
    ds_read_b128 v[86:89], v135 offset:0
    ds_read_b128 v[90:93], v135 offset:2048
    v_mfma_f32_16x16x32_bf16 v[50:53], v[110:113], v[70:73], v[50:53]
    ds_read_b128 v[94:97], v135 offset:4096
    ds_read_b128 v[98:101], v135 offset:6144
    v_mfma_f32_16x16x32_bf16 v[34:37], v[106:109], v[74:77], v[34:37]
    ds_read_b128 v[102:105], v135 offset:8192
    v_mfma_f32_16x16x32_bf16 v[54:57], v[110:113], v[74:77], v[54:57]
    v_mfma_f32_16x16x32_bf16 v[38:41], v[106:109], v[78:81], v[38:41]
    v_mfma_f32_16x16x32_bf16 v[58:61], v[110:113], v[78:81], v[58:61]
    v_mfma_f32_16x16x32_bf16 v[42:45], v[106:109], v[82:85], v[42:45]
    v_mfma_f32_16x16x32_bf16 v[62:65], v[110:113], v[82:85], v[62:65]
    v_add_u32 v134, 0xac00, v134
    v_add_u32 v136, 0xac00, v136
    v_add_u32 v135, 0xac00, v135
    s_mov_b64 s[64:65], 0xffff
    s_lshl_b64 s[64:65], s[64:65], s52
    s_and_b32 s53, s56, 1
    s_lshr_b32 s52, s56, 1
    s_mul_i32 s72, s52, 40960
    s_mul_i32 s86, s52, 98304
    s_lshl_b32 s52, s52, 7
    s_lshl3_add_u32 s60, s53, s60
    s_lshl2_add_u32 s60, s60, s52
    s_add_u32 s60, s60, 29376512
    s_lshl3_add_u32 s78, s53, s44
    s_lshl2_add_u32 s78, s78, s52
    s_add_u32 s78, s78, 29392896
    s_lshl_b32 s85, s53, 5
    s_lshl1_add_u32 s61, s85, s52
    s_add_u32 s61, s61, 29376512
    s_add_u32 s85, s85, s52
    s_add_u32 s85, s85, 29409280
    s_mul_i32 s52, s53, 10240
    s_add_u32 s72, s72, s52
    s_mul_i32 s52, s53, 24576
    s_add_u32 s86, s86, s52
    s_add_u32 s86, s86, 8388608
    s_add_u32 s52, s43, 0
    s_and_b32 s52, s52, 3
    s_lshl_b32 s52, s52, 11
    s_add_u32 s68, s72, s52
    s_waitcnt lgkmcnt(0)
    s_barrier
    ds_read_b64_tr_b16 v[106:107], v136 offset:0
    ds_read_b64_tr_b16 v[108:109], v136 offset:8448
    v_mfma_f32_16x16x32_bf16 v[26:29], v[114:117], v[86:89], v[26:29]
    ds_read_b64_tr_b16 v[110:111], v136 offset:32
    ds_read_b64_tr_b16 v[112:113], v136 offset:8480
    v_mfma_f32_16x16x32_bf16 v[46:49], v[118:121], v[86:89], v[46:49]
    ds_read_b128 v[66:69], v134 offset:0
    ds_read_b128 v[70:73], v134 offset:2048
    v_mfma_f32_16x16x32_bf16 v[30:33], v[114:117], v[90:93], v[30:33]
    ds_read_b128 v[74:77], v134 offset:4096
    ds_read_b128 v[78:81], v134 offset:6144
    v_mfma_f32_16x16x32_bf16 v[50:53], v[118:121], v[90:93], v[50:53]
    ds_read_b128 v[82:85], v134 offset:8192
    v_mfma_f32_16x16x32_bf16 v[34:37], v[114:117], v[94:97], v[34:37]
    v_mfma_f32_16x16x32_bf16 v[54:57], v[118:121], v[94:97], v[54:57]
    v_mfma_f32_16x16x32_bf16 v[38:41], v[114:117], v[98:101], v[38:41]
    v_mfma_f32_16x16x32_bf16 v[58:61], v[118:121], v[98:101], v[58:61]
    v_mfma_f32_16x16x32_bf16 v[42:45], v[114:117], v[102:105], v[42:45]
    v_mfma_f32_16x16x32_bf16 v[62:65], v[118:121], v[102:105], v[62:65]
    s_cmp_eq_u32 s62, 7
    s_cbranch_scc1 .cap_51
.capb_52:
    s_cmp_eq_u32 s63, 7
    s_cbranch_scc1 .cap_53
.capb_54:
    s_waitcnt lgkmcnt(0)
    v_mfma_f32_16x16x32_bf16 v[26:29], v[106:109], v[66:69], v[26:29]
    ds_read_b64_tr_b16 v[114:115], v136 offset:512
    ds_read_b64_tr_b16 v[116:117], v136 offset:8960
    v_mfma_f32_16x16x32_bf16 v[46:49], v[110:113], v[66:69], v[46:49]
    ds_read_b64_tr_b16 v[118:119], v136 offset:544
    ds_read_b64_tr_b16 v[120:121], v136 offset:8992
    v_mfma_f32_16x16x32_bf16 v[30:33], v[106:109], v[70:73], v[30:33]
    ds_read_b128 v[86:89], v135 offset:0
    ds_read_b128 v[90:93], v135 offset:2048
    v_mfma_f32_16x16x32_bf16 v[50:53], v[110:113], v[70:73], v[50:53]
    ds_read_b128 v[94:97], v135 offset:4096
    ds_read_b128 v[98:101], v135 offset:6144
    v_mfma_f32_16x16x32_bf16 v[34:37], v[106:109], v[74:77], v[34:37]
    ds_read_b128 v[102:105], v135 offset:8192
    v_mfma_f32_16x16x32_bf16 v[54:57], v[110:113], v[74:77], v[54:57]
    v_mfma_f32_16x16x32_bf16 v[38:41], v[106:109], v[78:81], v[38:41]
    v_mfma_f32_16x16x32_bf16 v[58:61], v[110:113], v[78:81], v[58:61]
    v_mfma_f32_16x16x32_bf16 v[42:45], v[106:109], v[82:85], v[42:45]
    v_mfma_f32_16x16x32_bf16 v[62:65], v[110:113], v[82:85], v[62:65]
    v_add_u32 v134, 0xac00, v134
    v_add_u32 v136, 0xac00, v136
    v_add_u32 v135, 0xac00, v135
    s_add_u32 s52, s43, 1
    s_and_b32 s52, s52, 3
    s_lshl_b32 s52, s52, 11
    s_add_u32 s69, s72, s52
    s_add_u32 s52, s43, 2
    s_and_b32 s52, s52, 3
    s_lshl_b32 s52, s52, 11
    s_add_u32 s70, s72, s52
    s_add_u32 s52, s43, 3
    s_and_b32 s52, s52, 3
    s_lshl_b32 s52, s52, 11
    s_add_u32 s71, s72, s52
    s_add_u32 s72, s72, 8192
    s_lshl3_add_u32 s77, s56, s44
    s_lshl_b32 s77, s77, 7
    s_add_u32 s77, s77, 16777216
    s_add_u32 s76, s76, 4194304
    s_lshl_b32 s52, s73, 11
    s_add_u32 s75, s76, s52
    s_lshl_b32 s74, s74, 7
    s_add_u32 s74, s74, s57
    s_lshl4_add_u32 s76, s74, s76
    s_lshl_b32 s73, s73, 7
    s_lshl_b32 s53, s53, 5
    s_lshr_b32 s52, s54, 1
    s_add_u32 s53, s53, s52
    s_lshl_b32 s52, s43, 6
    s_waitcnt lgkmcnt(0)
    s_barrier
    ds_read_b64_tr_b16 v[106:107], v136 offset:0
    ds_read_b64_tr_b16 v[108:109], v136 offset:8448
    v_mfma_f32_16x16x32_bf16 v[26:29], v[114:117], v[86:89], v[26:29]
    ds_read_b64_tr_b16 v[110:111], v136 offset:32
    ds_read_b64_tr_b16 v[112:113], v136 offset:8480
    v_mfma_f32_16x16x32_bf16 v[46:49], v[118:121], v[86:89], v[46:49]
    ds_read_b128 v[66:69], v134 offset:0
    ds_read_b128 v[70:73], v134 offset:2048
    v_mfma_f32_16x16x32_bf16 v[30:33], v[114:117], v[90:93], v[30:33]
    ds_read_b128 v[74:77], v134 offset:4096
    ds_read_b128 v[78:81], v134 offset:6144
    v_mfma_f32_16x16x32_bf16 v[50:53], v[118:121], v[90:93], v[50:53]
    ds_read_b128 v[82:85], v134 offset:8192
    v_mfma_f32_16x16x32_bf16 v[34:37], v[114:117], v[94:97], v[34:37]
    v_mfma_f32_16x16x32_bf16 v[54:57], v[118:121], v[94:97], v[54:57]
    v_mfma_f32_16x16x32_bf16 v[38:41], v[114:117], v[98:101], v[38:41]
    v_mfma_f32_16x16x32_bf16 v[58:61], v[118:121], v[98:101], v[58:61]
    v_mfma_f32_16x16x32_bf16 v[42:45], v[114:117], v[102:105], v[42:45]
    v_mfma_f32_16x16x32_bf16 v[62:65], v[118:121], v[102:105], v[62:65]
    s_cmp_eq_u32 s62, 8
    s_cbranch_scc1 .cap_55
.capb_56:
    s_cmp_eq_u32 s63, 8
    s_cbranch_scc1 .cap_57
.capb_58:
    s_waitcnt lgkmcnt(0)
    v_mfma_f32_16x16x32_bf16 v[26:29], v[106:109], v[66:69], v[26:29]
    ds_read_b64_tr_b16 v[114:115], v136 offset:512
    ds_read_b64_tr_b16 v[116:117], v136 offset:8960
    v_mfma_f32_16x16x32_bf16 v[46:49], v[110:113], v[66:69], v[46:49]
    ds_read_b64_tr_b16 v[118:119], v136 offset:544
    ds_read_b64_tr_b16 v[120:121], v136 offset:8992
    v_mfma_f32_16x16x32_bf16 v[30:33], v[106:109], v[70:73], v[30:33]
    ds_read_b128 v[86:89], v135 offset:0
    ds_read_b128 v[90:93], v135 offset:2048
    v_mfma_f32_16x16x32_bf16 v[50:53], v[110:113], v[70:73], v[50:53]
    ds_read_b128 v[94:97], v135 offset:4096
    ds_read_b128 v[98:101], v135 offset:6144
    v_mfma_f32_16x16x32_bf16 v[34:37], v[106:109], v[74:77], v[34:37]
    ds_read_b128 v[102:105], v135 offset:8192
    v_mfma_f32_16x16x32_bf16 v[54:57], v[110:113], v[74:77], v[54:57]
    v_mfma_f32_16x16x32_bf16 v[38:41], v[106:109], v[78:81], v[38:41]
    v_mfma_f32_16x16x32_bf16 v[58:61], v[110:113], v[78:81], v[58:61]
    v_mfma_f32_16x16x32_bf16 v[42:45], v[106:109], v[82:85], v[42:45]
    v_mfma_f32_16x16x32_bf16 v[62:65], v[110:113], v[82:85], v[62:65]
    v_add_u32 v134, 0xfffea800, v134
    v_add_u32 v136, 0xfffea800, v136
    v_add_u32 v135, 0xfffea800, v135
    s_add_u32 s53, s53, s52
    s_mul_i32 s53, s53, 1280
    s_add_u32 s73, s73, s53
    s_add_u32 s74, s74, s53
    s_lshl2_add_u32 s53, s41, s54
    s_lshl_b32 s79, s53, 7
    s_lshl2_add_u32 s84, s42, s79
    s_add_u32 s84, s84, 29409280
    s_add_u32 s79, s79, 29392896
    s_lshl_b32 s80, s53, 11
    s_add_u32 s80, s80, 16777216
    s_mul_i32 s81, s53, 40960
    s_add_u32 s81, s81, 4194304
    s_mul_i32 s83, s53, 98304
    s_mul_i32 s52, s42, 3072
    s_add_u32 s83, s83, s52
    s_add_u32 s83, s83, 8388608
    s_bitcmp1_b32 s42, 0
    s_cselect_b32 s52, 1024, 0
    s_cselect_b32 s53, 0, 2048
    s_add_u32 s82, s83, s52
    s_add_u32 s83, s83, s53
    s_and_b32 s52, s41, 1
    s_mul_i32 s87, s52, 10240
    s_add_u32 s81, s81, s87
    s_lshl_b32 s87, s87, 1
    s_sub_u32 s87, 2048, s87
    s_waitcnt lgkmcnt(0)
    s_barrier
    ds_read_b64_tr_b16 v[106:107], v136 offset:0
    ds_read_b64_tr_b16 v[108:109], v136 offset:8448
    v_mfma_f32_16x16x32_bf16 v[26:29], v[114:117], v[86:89], v[26:29]
    ds_read_b64_tr_b16 v[110:111], v136 offset:32
    ds_read_b64_tr_b16 v[112:113], v136 offset:8480
    v_mfma_f32_16x16x32_bf16 v[46:49], v[118:121], v[86:89], v[46:49]
    ds_read_b128 v[66:69], v134 offset:0
    ds_read_b128 v[70:73], v134 offset:2048
    v_mfma_f32_16x16x32_bf16 v[30:33], v[114:117], v[90:93], v[30:33]
    ds_read_b128 v[74:77], v134 offset:4096
    ds_read_b128 v[78:81], v134 offset:6144
    v_mfma_f32_16x16x32_bf16 v[50:53], v[118:121], v[90:93], v[50:53]
    ds_read_b128 v[82:85], v134 offset:8192
    v_mfma_f32_16x16x32_bf16 v[34:37], v[114:117], v[94:97], v[34:37]
    v_mfma_f32_16x16x32_bf16 v[54:57], v[118:121], v[94:97], v[54:57]
    v_mfma_f32_16x16x32_bf16 v[38:41], v[114:117], v[98:101], v[38:41]
    v_mfma_f32_16x16x32_bf16 v[58:61], v[118:121], v[98:101], v[58:61]
    v_mfma_f32_16x16x32_bf16 v[42:45], v[114:117], v[102:105], v[42:45]
    v_mfma_f32_16x16x32_bf16 v[62:65], v[118:121], v[102:105], v[62:65]
    s_cmp_eq_u32 s62, 9
    s_cbranch_scc1 .cap_59
.capb_60:
    s_cmp_eq_u32 s63, 9
    s_cbranch_scc1 .cap_61
.capb_62:
    s_waitcnt lgkmcnt(0)
    v_mfma_f32_16x16x32_bf16 v[26:29], v[106:109], v[66:69], v[26:29]
    ds_read_b64_tr_b16 v[114:115], v136 offset:512
    ds_read_b64_tr_b16 v[116:117], v136 offset:8960
    v_mfma_f32_16x16x32_bf16 v[46:49], v[110:113], v[66:69], v[46:49]
    ds_read_b64_tr_b16 v[118:119], v136 offset:544
    ds_read_b64_tr_b16 v[120:121], v136 offset:8992
    v_mfma_f32_16x16x32_bf16 v[30:33], v[106:109], v[70:73], v[30:33]
    ds_read_b128 v[86:89], v135 offset:0
    ds_read_b128 v[90:93], v135 offset:2048
    v_mfma_f32_16x16x32_bf16 v[50:53], v[110:113], v[70:73], v[50:53]
    ds_read_b128 v[94:97], v135 offset:4096
    ds_read_b128 v[98:101], v135 offset:6144
    v_mfma_f32_16x16x32_bf16 v[34:37], v[106:109], v[74:77], v[34:37]
    ds_read_b128 v[102:105], v135 offset:8192
    v_mfma_f32_16x16x32_bf16 v[54:57], v[110:113], v[74:77], v[54:57]
    v_mfma_f32_16x16x32_bf16 v[38:41], v[106:109], v[78:81], v[38:41]
    v_mfma_f32_16x16x32_bf16 v[58:61], v[110:113], v[78:81], v[58:61]
    v_mfma_f32_16x16x32_bf16 v[42:45], v[106:109], v[82:85], v[42:45]
    v_mfma_f32_16x16x32_bf16 v[62:65], v[110:113], v[82:85], v[62:65]
    v_mov_b32 v14, 161536
    ds_read_b64 v[74:75], v139 offset:512
    ds_read_b64 v[66:67], v139 offset:0
    ds_read_b64 v[68:69], v139 offset:128
    ds_read_b64 v[70:71], v139 offset:256
    ds_read_b64 v[72:73], v139 offset:384
    ds_read_b32 v17, v14
    s_waitcnt lgkmcnt(6)
    v_mfma_f32_16x16x32_bf16 v[42:45], v[114:117], v[102:105], v[42:45]
    v_mfma_f32_16x16x32_bf16 v[62:65], v[118:121], v[102:105], v[62:65]
    v_mfma_f32_16x16x32_bf16 v[26:29], v[114:117], v[86:89], v[26:29]
    v_mfma_f32_16x16x32_bf16 v[46:49], v[118:121], v[86:89], v[46:49]
    v_mfma_f32_16x16x32_bf16 v[30:33], v[114:117], v[90:93], v[30:33]
    v_mfma_f32_16x16x32_bf16 v[50:53], v[118:121], v[90:93], v[50:53]
    v_mfma_f32_16x16x32_bf16 v[34:37], v[114:117], v[94:97], v[34:37]
    s_nop 1
    v_mov_b32_dpp v78, v42 row_newbcast:0 row_mask:0xf bank_mask:0xf
    v_mov_b32_dpp v79, v43 row_newbcast:0 row_mask:0xf bank_mask:0xf
    v_mfma_f32_16x16x32_bf16 v[54:57], v[118:121], v[94:97], v[54:57]
    v_mov_b32_dpp v80, v44 row_newbcast:0 row_mask:0xf bank_mask:0xf
    v_mov_b32_dpp v81, v45 row_newbcast:0 row_mask:0xf bank_mask:0xf
    v_mfma_f32_16x16x32_bf16 v[38:41], v[114:117], v[98:101], v[38:41]
    v_mov_b32_dpp v82, v62 row_newbcast:0 row_mask:0xf bank_mask:0xf
    v_mov_b32_dpp v83, v63 row_newbcast:0 row_mask:0xf bank_mask:0xf
    v_mfma_f32_16x16x32_bf16 v[58:61], v[118:121], v[98:101], v[58:61]
    v_mov_b32_dpp v84, v64 row_newbcast:0 row_mask:0xf bank_mask:0xf
    v_mov_b32_dpp v85, v65 row_newbcast:0 row_mask:0xf bank_mask:0xf
    s_waitcnt lgkmcnt(0)
    v_readfirstlane_b32 s46, v17
    v_pk_mul_f32 v[42:43], v[42:43], v[74:75] op_sel_hi:[1,0]
    v_pk_mul_f32 v[44:45], v[44:45], v[74:75] op_sel_hi:[1,0]
    v_pk_fma_f32 v[42:43], v[74:75], v[78:79], v[42:43] op_sel:[1,0,0] op_sel_hi:[1,1,1] neg_lo:[1,0,0] neg_hi:[1,0,0]
    v_pk_fma_f32 v[44:45], v[74:75], v[80:81], v[44:45] op_sel:[1,0,0] op_sel_hi:[1,1,1] neg_lo:[1,0,0] neg_hi:[1,0,0]
    v_cvt_pk_bf16_f32 v106, v42, v43
    v_cvt_pk_bf16_f32 v107, v44, v45
    ds_write_b64 v138, v[106:107] offset:31232
    v_pk_mul_f32 v[26:27], v[26:27], v[66:67] op_sel_hi:[1,0]
    v_pk_mul_f32 v[28:29], v[28:29], v[66:67] op_sel_hi:[1,0]
    v_pk_fma_f32 v[26:27], v[66:67], v[78:79], v[26:27] op_sel:[1,0,0] op_sel_hi:[1,1,1] neg_lo:[1,0,0] neg_hi:[1,0,0]
    v_pk_fma_f32 v[28:29], v[66:67], v[80:81], v[28:29] op_sel:[1,0,0] op_sel_hi:[1,1,1] neg_lo:[1,0,0] neg_hi:[1,0,0]
    v_cvt_pk_bf16_f32 v108, v26, v27
    v_cvt_pk_bf16_f32 v109, v28, v29
    ds_write_b64 v138, v[108:109] offset:0
    v_pk_mul_f32 v[30:31], v[30:31], v[68:69] op_sel_hi:[1,0]
    v_pk_mul_f32 v[32:33], v[32:33], v[68:69] op_sel_hi:[1,0]
    v_pk_fma_f32 v[30:31], v[68:69], v[78:79], v[30:31] op_sel:[1,0,0] op_sel_hi:[1,1,1] neg_lo:[1,0,0] neg_hi:[1,0,0]
    v_pk_fma_f32 v[32:33], v[68:69], v[80:81], v[32:33] op_sel:[1,0,0] op_sel_hi:[1,1,1] neg_lo:[1,0,0] neg_hi:[1,0,0]
    v_cvt_pk_bf16_f32 v110, v30, v31
    v_cvt_pk_bf16_f32 v111, v32, v33
    ds_write_b64 v138, v[110:111] offset:7808
    v_pk_mul_f32 v[34:35], v[34:35], v[70:71] op_sel_hi:[1,0]
    v_pk_mul_f32 v[36:37], v[36:37], v[70:71] op_sel_hi:[1,0]
    v_pk_fma_f32 v[34:35], v[70:71], v[78:79], v[34:35] op_sel:[1,0,0] op_sel_hi:[1,1,1] neg_lo:[1,0,0] neg_hi:[1,0,0]
    v_pk_fma_f32 v[36:37], v[70:71], v[80:81], v[36:37] op_sel:[1,0,0] op_sel_hi:[1,1,1] neg_lo:[1,0,0] neg_hi:[1,0,0]
    v_cvt_pk_bf16_f32 v112, v34, v35
    v_cvt_pk_bf16_f32 v113, v36, v37
    ds_write_b64 v138, v[112:113] offset:15616
    v_pk_mul_f32 v[38:39], v[38:39], v[72:73] op_sel_hi:[1,0]
    v_pk_mul_f32 v[40:41], v[40:41], v[72:73] op_sel_hi:[1,0]
    v_pk_fma_f32 v[38:39], v[72:73], v[78:79], v[38:39] op_sel:[1,0,0] op_sel_hi:[1,1,1] neg_lo:[1,0,0] neg_hi:[1,0,0]
    v_pk_fma_f32 v[40:41], v[72:73], v[80:81], v[40:41] op_sel:[1,0,0] op_sel_hi:[1,1,1] neg_lo:[1,0,0] neg_hi:[1,0,0]
    v_cvt_pk_bf16_f32 v106, v38, v39
    v_cvt_pk_bf16_f32 v107, v40, v41
    ds_write_b64 v138, v[106:107] offset:23424
    s_cmp_eq_u32 s38, 7
    s_cbranch_scc1 .p1sk_63
    v_pk_mul_f32 v[62:63], v[62:63], v[74:75] op_sel_hi:[1,0]
    v_pk_mul_f32 v[64:65], v[64:65], v[74:75] op_sel_hi:[1,0]
    v_pk_fma_f32 v[62:63], v[74:75], v[82:83], v[62:63] op_sel:[1,0,0] op_sel_hi:[1,1,1] neg_lo:[1,0,0] neg_hi:[1,0,0]
    v_pk_fma_f32 v[64:65], v[74:75], v[84:85], v[64:65] op_sel:[1,0,0] op_sel_hi:[1,1,1] neg_lo:[1,0,0] neg_hi:[1,0,0]
    v_cvt_pk_bf16_f32 v106, v62, v63
    v_cvt_pk_bf16_f32 v107, v64, v65
    ds_write_b64 v138, v[106:107] offset:31264
    v_pk_mul_f32 v[46:47], v[46:47], v[66:67] op_sel_hi:[1,0]
    v_pk_mul_f32 v[48:49], v[48:49], v[66:67] op_sel_hi:[1,0]
    v_pk_fma_f32 v[46:47], v[66:67], v[82:83], v[46:47] op_sel:[1,0,0] op_sel_hi:[1,1,1] neg_lo:[1,0,0] neg_hi:[1,0,0]
    v_pk_fma_f32 v[48:49], v[66:67], v[84:85], v[48:49] op_sel:[1,0,0] op_sel_hi:[1,1,1] neg_lo:[1,0,0] neg_hi:[1,0,0]
    v_cvt_pk_bf16_f32 v108, v46, v47
    v_cvt_pk_bf16_f32 v109, v48, v49
    ds_write_b64 v138, v[108:109] offset:32
    v_pk_mul_f32 v[50:51], v[50:51], v[68:69] op_sel_hi:[1,0]
    v_pk_mul_f32 v[52:53], v[52:53], v[68:69] op_sel_hi:[1,0]
    v_pk_fma_f32 v[50:51], v[68:69], v[82:83], v[50:51] op_sel:[1,0,0] op_sel_hi:[1,1,1] neg_lo:[1,0,0] neg_hi:[1,0,0]
    v_pk_fma_f32 v[52:53], v[68:69], v[84:85], v[52:53] op_sel:[1,0,0] op_sel_hi:[1,1,1] neg_lo:[1,0,0] neg_hi:[1,0,0]
    v_cvt_pk_bf16_f32 v110, v50, v51
    v_cvt_pk_bf16_f32 v111, v52, v53
    ds_write_b64 v138, v[110:111] offset:7840
    v_pk_mul_f32 v[54:55], v[54:55], v[70:71] op_sel_hi:[1,0]
    v_pk_mul_f32 v[56:57], v[56:57], v[70:71] op_sel_hi:[1,0]
    v_pk_fma_f32 v[54:55], v[70:71], v[82:83], v[54:55] op_sel:[1,0,0] op_sel_hi:[1,1,1] neg_lo:[1,0,0] neg_hi:[1,0,0]
    v_pk_fma_f32 v[56:57], v[70:71], v[84:85], v[56:57] op_sel:[1,0,0] op_sel_hi:[1,1,1] neg_lo:[1,0,0] neg_hi:[1,0,0]
    v_cvt_pk_bf16_f32 v112, v54, v55
    v_cvt_pk_bf16_f32 v113, v56, v57
    ds_write_b64 v138, v[112:113] offset:15648
    v_pk_mul_f32 v[58:59], v[58:59], v[72:73] op_sel_hi:[1,0]
    v_pk_mul_f32 v[60:61], v[60:61], v[72:73] op_sel_hi:[1,0]
    v_pk_fma_f32 v[58:59], v[72:73], v[82:83], v[58:59] op_sel:[1,0,0] op_sel_hi:[1,1,1] neg_lo:[1,0,0] neg_hi:[1,0,0]
    v_pk_fma_f32 v[60:61], v[72:73], v[84:85], v[60:61] op_sel:[1,0,0] op_sel_hi:[1,1,1] neg_lo:[1,0,0] neg_hi:[1,0,0]
    v_cvt_pk_bf16_f32 v106, v58, v59
    v_cvt_pk_bf16_f32 v107, v60, v61
    ds_write_b64 v138, v[106:107] offset:23456
.p1sk_63:
    s_waitcnt lgkmcnt(0)
    s_barrier
    ds_read2_b64 v[26:29], v142 offset0:0 offset1:4
    ds_read2_b64 v[34:37], v142 offset0:20 offset1:24
    ds_read2_b64 v[42:45], v143 offset0:20 offset1:24
    ds_read2_b64 v[30:33], v142 offset0:5 offset1:9
    ds_read2_b64 v[38:41], v142 offset0:25 offset1:29
    ds_read2_b64 v[46:49], v143 offset0:25 offset1:29
    ds_read_b64_tr_b16 v[50:51], v145 offset:320
    ds_read_b64_tr_b16 v[52:53], v144 offset:320
    ds_read_b64_tr_b16 v[58:59], v147 offset:352
    ds_read_b64_tr_b16 v[60:61], v146 offset:352
    ds_read_b64_tr_b16 v[54:55], v145 offset:360
    ds_read_b64_tr_b16 v[56:57], v144 offset:360
    ds_read_b64_tr_b16 v[62:63], v147 offset:392
    ds_read_b64_tr_b16 v[64:65], v146 offset:392
    s_waitcnt lgkmcnt(11)
    v_and_b32 v28, v28, v137
    v_and_b32 v29, v29, v137
    s_nop 1
    v_mfma_f32_16x16x32_bf16 v[66:69], v[34:37], v[26:29], v[122:125]
    v_mfma_f32_16x16x32_bf16 v[74:77], v[42:45], v[26:29], v[126:129]
    s_waitcnt lgkmcnt(8)
    v_and_b32 v32, v32, v137
    v_and_b32 v33, v33, v137
    s_nop 1
    v_mfma_f32_16x16x32_bf16 v[70:73], v[38:41], v[30:33], v[122:125]
    v_mfma_f32_16x16x32_bf16 v[78:81], v[46:49], v[30:33], v[126:129]
    s_nop 0
    v_max_f32 v66, v66, v74
    v_max_f32 v67, v67, v75
    v_max_f32 v68, v68, v76
    v_max_f32 v69, v69, v77
    v_max3_f32 v14, v66, v67, v68
    v_max_f32 v14, v14, v69
    s_nop 0
    v_max_f32 v70, v70, v78
    v_max_f32 v71, v71, v79
    v_max_f32 v72, v72, v80
    v_max_f32 v73, v73, v81
    v_max3_f32 v15, v70, v71, v72
    v_max_f32 v15, v15, v73
    v_mov_b32 v16, v14
    v_mov_b32 v17, v15
    s_nop 0
    v_permlane32_swap_b32 v14, v16
    v_permlane32_swap_b32 v15, v17
    v_max_f32 v14, v14, v16
    v_max_f32 v15, v15, v17
    v_mov_b32 v16, v14
    v_mov_b32 v17, v15
    s_nop 0
    v_permlane16_swap_b32 v14, v16
    v_permlane16_swap_b32 v15, v17
    v_max_f32 v14, v14, v16
    v_max_f32 v15, v15, v17
    v_pk_mul_f32 v[14:15], v[14:15], s[66:67]
    v_pk_fma_f32 v[66:67], v[66:67], s[66:67], v[14:15] op_sel:[0,0,0] op_sel_hi:[1,1,0] neg_lo:[0,0,1] neg_hi:[0,0,1]
    v_pk_fma_f32 v[68:69], v[68:69], s[66:67], v[14:15] op_sel:[0,0,0] op_sel_hi:[1,1,0] neg_lo:[0,0,1] neg_hi:[0,0,1]
    v_pk_fma_f32 v[70:71], v[70:71], s[66:67], v[14:15] op_sel:[0,0,1] op_sel_hi:[1,1,1] neg_lo:[0,0,1] neg_hi:[0,0,1]
    v_pk_fma_f32 v[72:73], v[72:73], s[66:67], v[14:15] op_sel:[0,0,1] op_sel_hi:[1,1,1] neg_lo:[0,0,1] neg_hi:[0,0,1]
    v_exp_f32 v66, v66
    v_exp_f32 v67, v67
    v_exp_f32 v68, v68
    v_exp_f32 v69, v69
    v_exp_f32 v70, v70
    v_exp_f32 v71, v71
    v_exp_f32 v72, v72
    v_exp_f32 v73, v73
    v_pk_add_f32 v[74:75], v[66:67], v[68:69]
    v_pk_add_f32 v[78:79], v[70:71], v[72:73]
    v_add_f32 v14, v74, v75
    v_add_f32 v15, v78, v79
    v_mov_b32 v16, v14
    v_mov_b32 v17, v15
    s_nop 0
    v_permlane32_swap_b32 v14, v16
    v_permlane32_swap_b32 v15, v17
    v_add_f32 v14, v14, v16
    v_add_f32 v15, v15, v17
    v_mov_b32 v16, v14
    v_mov_b32 v17, v15
    s_nop 0
    v_permlane16_swap_b32 v14, v16
    v_permlane16_swap_b32 v15, v17
    v_add_f32 v14, v14, v16
    v_add_f32 v15, v15, v17
    v_rcp_f32 v14, v14
    v_rcp_f32 v15, v15
    s_nop 0
    v_pk_mul_f32 v[66:67], v[66:67], v[14:15] op_sel:[0,0] op_sel_hi:[1,0]
    v_pk_mul_f32 v[68:69], v[68:69], v[14:15] op_sel:[0,0] op_sel_hi:[1,0]
    v_cvt_pk_bf16_f32 v66, v66, v67
    v_cvt_pk_bf16_f32 v67, v68, v69
    v_and_b32 v74, v66, v132
    v_and_b32 v75, v67, v133
    v_and_b32 v76, v66, v130
    v_and_b32 v77, v67, v131
    s_waitcnt lgkmcnt(0)
    s_nop 0
    v_mfma_f32_16x16x32_bf16 v[26:29], v[50:53], v[74:77], 0
    v_mfma_f32_16x16x32_bf16 v[34:37], v[58:61], v[74:77], 0
    v_pk_mul_f32 v[70:71], v[70:71], v[14:15] op_sel:[0,1] op_sel_hi:[1,1]
    v_pk_mul_f32 v[72:73], v[72:73], v[14:15] op_sel:[0,1] op_sel_hi:[1,1]
    v_cvt_pk_bf16_f32 v70, v70, v71
    v_cvt_pk_bf16_f32 v71, v72, v73
    v_and_b32 v78, v70, v132
    v_and_b32 v79, v71, v133
    v_and_b32 v80, v70, v130
    v_and_b32 v81, v71, v131
    s_nop 1
    v_mfma_f32_16x16x32_bf16 v[30:33], v[54:57], v[78:81], 0
    v_mfma_f32_16x16x32_bf16 v[38:41], v[62:65], v[78:81], 0
    v_cvt_pk_bf16_f32 v82, v26, v27
    v_cvt_pk_bf16_f32 v83, v28, v29
    v_cvt_pk_bf16_f32 v86, v34, v35
    v_cvt_pk_bf16_f32 v87, v36, v37
    s_nop 2
    v_cvt_pk_bf16_f32 v84, v30, v31
    v_cvt_pk_bf16_f32 v85, v32, v33
    v_cvt_pk_bf16_f32 v88, v38, v39
    v_cvt_pk_bf16_f32 v89, v40, v41
    buffer_store_dwordx4 v[82:85], v1, s[4:7], s58 offen sc1
    s_mov_b64 exec, s[64:65]
    buffer_store_dwordx4 v[86:89], v1, s[4:7], s59 offen sc1
    s_mov_b64 exec, -1
    v_mov_b32 v14, s45
    s_mov_b64 exec, 1
    s_waitcnt vmcnt(0)
    s_cmp_eq_u32 s46, 0
    s_cbranch_scc1 .slow_64
    buffer_store_dword v14, off, s[4:7], s60
.join_65:
    s_mov_b64 exec, -1
    s_barrier
    s_cmp_ge_u32 s38, 4
    s_cbranch_scc1 .helper_66
    s_setprio 3
    buffer_load_dword v16, v22, s[4:7], s61 offen sc1
    ds_read_b64_tr_b16 v[66:67], v20 offset:0
    ds_read_b64_tr_b16 v[68:69], v20 offset:256
    ds_read_b64_tr_b16 v[70:71], v20 offset:32
    ds_read_b64_tr_b16 v[72:73], v20 offset:288
    ds_read_b64_tr_b16 v[74:75], v20 offset:64
    ds_read_b64_tr_b16 v[76:77], v20 offset:320
    ds_read_b64_tr_b16 v[78:79], v20 offset:96
    ds_read_b64_tr_b16 v[80:81], v20 offset:352
    ds_read_b128 v[82:85], v21 offset:8448
    v_lshlrev_b32 v26, 16, v2
    v_and_b32 v27, 0xffff0000, v2
    v_lshlrev_b32 v28, 16, v3
    v_and_b32 v29, 0xffff0000, v3
    v_lshlrev_b32 v30, 16, v4
    v_and_b32 v31, 0xffff0000, v4
    v_lshlrev_b32 v32, 16, v5
    v_and_b32 v33, 0xffff0000, v5
    v_lshlrev_b32 v34, 16, v6
    v_and_b32 v35, 0xffff0000, v6
    v_lshlrev_b32 v36, 16, v7
    v_and_b32 v37, 0xffff0000, v7
    v_lshlrev_b32 v38, 16, v8
    v_and_b32 v39, 0xffff0000, v8
    v_lshlrev_b32 v40, 16, v9
    v_and_b32 v41, 0xffff0000, v9
    v_lshlrev_b32 v42, 16, v10
    v_and_b32 v43, 0xffff0000, v10
    v_lshlrev_b32 v44, 16, v11
    v_and_b32 v45, 0xffff0000, v11
    s_mov_b32 s47, 65536
.poll_67:
    buffer_load_dword v15, v22, s[4:7], s61 offen sc1
    s_waitcnt vmcnt(1)
    v_cmp_ne_u32 vcc, s45, v16
    s_cmp_eq_u64 vcc, 0
    s_cbranch_scc1 .polld_68
    buffer_load_dword v16, v22, s[4:7], s61 offen sc1
    s_waitcnt vmcnt(1)
    v_cmp_ne_u32 vcc, s45, v15
    s_cmp_eq_u64 vcc, 0
    s_cbranch_scc1 .polld_68
    s_sub_u32 s47, s47, 1
    s_cbranch_scc0 .poll_67
.polld_68:
    buffer_load_dwordx4 v[90:93], v24, s[4:7], s68 offen offset:0 sc1
    buffer_load_dwordx4 v[94:97], v25, s[4:7], s68 offen offset:0 sc1
    buffer_load_dwordx4 v[98:101], v24, s[4:7], s68 offen offset:1024 sc1
    buffer_load_dwordx4 v[102:105], v25, s[4:7], s68 offen offset:1024 sc1
    buffer_load_dwordx4 v[106:109], v24, s[4:7], s69 offen offset:0 sc1
    buffer_load_dwordx4 v[110:113], v25, s[4:7], s69 offen offset:0 sc1
    buffer_load_dwordx4 v[114:117], v24, s[4:7], s69 offen offset:1024 sc1
    buffer_load_dwordx4 v[118:121], v25, s[4:7], s69 offen offset:1024 sc1
    buffer_load_dwordx4 v[122:125], v24, s[4:7], s70 offen offset:0 sc1
    buffer_load_dwordx4 v[126:129], v25, s[4:7], s70 offen offset:0 sc1
    buffer_load_dwordx4 v[130:133], v24, s[4:7], s70 offen offset:1024 sc1
    buffer_load_dwordx4 v[134:137], v25, s[4:7], s70 offen offset:1024 sc1
    buffer_load_dwordx4 v[138:141], v24, s[4:7], s71 offen offset:0 sc1
    buffer_load_dwordx4 v[142:145], v25, s[4:7], s71 offen offset:0 sc1
    buffer_load_dwordx4 v[146:149], v24, s[4:7], s71 offen offset:1024 sc1
    buffer_load_dwordx4 v[150:153], v25, s[4:7], s71 offen offset:1024 sc1
    s_barrier
    s_waitcnt vmcnt(15) lgkmcnt(7)
    v_mfma_f32_16x16x32_bf16 v[26:29], v[66:69], v[90:93], v[26:29]
    ds_read_b64_tr_b16 v[86:87], v20 offset:10496
    s_waitcnt vmcnt(14)
    v_mfma_f32_16x16x32_bf16 v[46:49], v[66:69], v[94:97], 0
    ds_read_b64_tr_b16 v[88:89], v20 offset:10752
    s_waitcnt lgkmcnt(7)
    v_mfma_f32_16x16x32_bf16 v[30:33], v[70:73], v[90:93], v[30:33]
    ds_read_b64_tr_b16 v[66:67], v20 offset:10528
    v_mfma_f32_16x16x32_bf16 v[50:53], v[70:73], v[94:97], 0
    ds_read_b64_tr_b16 v[68:69], v20 offset:10784
    s_waitcnt lgkmcnt(7)
    v_mfma_f32_16x16x32_bf16 v[34:37], v[74:77], v[90:93], v[34:37]
    ds_read_b64_tr_b16 v[70:71], v20 offset:10560
    v_mfma_f32_16x16x32_bf16 v[54:57], v[74:77], v[94:97], 0
    ds_read_b64_tr_b16 v[72:73], v20 offset:10816
    s_waitcnt lgkmcnt(7)
    v_mfma_f32_16x16x32_bf16 v[38:41], v[78:81], v[90:93], v[38:41]
    ds_read_b64_tr_b16 v[74:75], v20 offset:10592
    v_mfma_f32_16x16x32_bf16 v[58:61], v[78:81], v[94:97], 0
    ds_read_b64_tr_b16 v[76:77], v20 offset:10848
    s_waitcnt lgkmcnt(8)
    v_mfma_f32_16x16x32_bf16 v[42:45], v[82:85], v[90:93], v[42:45]
    ds_read_b128 v[78:81], v21 offset:18944
    buffer_load_dwordx4 v[90:93], v24, s[4:7], s72 offen offset:0 sc1
    v_mfma_f32_16x16x32_bf16 v[62:65], v[82:85], v[94:97], 0
    buffer_load_dwordx4 v[94:97], v25, s[4:7], s72 offen offset:0 sc1
    s_waitcnt vmcnt(14) lgkmcnt(7)
    v_mfma_f32_16x16x32_bf16 v[26:29], v[86:89], v[98:101], v[26:29]
    ds_read_b64_tr_b16 v[82:83], v20 offset:20992
    v_mfma_f32_16x16x32_bf16 v[46:49], v[86:89], v[102:105], v[46:49]
    ds_read_b64_tr_b16 v[84:85], v20 offset:21248
    s_waitcnt lgkmcnt(7)
    v_mfma_f32_16x16x32_bf16 v[30:33], v[66:69], v[98:101], v[30:33]
    ds_read_b64_tr_b16 v[86:87], v20 offset:21024
    v_mfma_f32_16x16x32_bf16 v[50:53], v[66:69], v[102:105], v[50:53]
    ds_read_b64_tr_b16 v[88:89], v20 offset:21280
    s_waitcnt lgkmcnt(7)
    v_mfma_f32_16x16x32_bf16 v[34:37], v[70:73], v[98:101], v[34:37]
    ds_read_b64_tr_b16 v[66:67], v20 offset:21056
    v_mfma_f32_16x16x32_bf16 v[54:57], v[70:73], v[102:105], v[54:57]
    ds_read_b64_tr_b16 v[68:69], v20 offset:21312
    s_waitcnt lgkmcnt(7)
    v_mfma_f32_16x16x32_bf16 v[38:41], v[74:77], v[98:101], v[38:41]
    ds_read_b64_tr_b16 v[70:71], v20 offset:21088
    v_mfma_f32_16x16x32_bf16 v[58:61], v[74:77], v[102:105], v[58:61]
    ds_read_b64_tr_b16 v[72:73], v20 offset:21344
    s_waitcnt lgkmcnt(8)
    v_mfma_f32_16x16x32_bf16 v[42:45], v[78:81], v[98:101], v[42:45]
    ds_read_b128 v[74:77], v21 offset:29440
    buffer_load_dwordx4 v[98:101], v24, s[4:7], s72 offen offset:1024 sc1
    v_mfma_f32_16x16x32_bf16 v[62:65], v[78:81], v[102:105], v[62:65]
    buffer_load_dwordx4 v[102:105], v25, s[4:7], s72 offen offset:1024 sc1
    s_waitcnt vmcnt(14) lgkmcnt(7)
    v_mfma_f32_16x16x32_bf16 v[26:29], v[82:85], v[106:109], v[26:29]
    ds_read_b64_tr_b16 v[78:79], v20 offset:31488
    v_mfma_f32_16x16x32_bf16 v[46:49], v[82:85], v[110:113], v[46:49]
    ds_read_b64_tr_b16 v[80:81], v20 offset:31744
    s_waitcnt lgkmcnt(7)
    v_mfma_f32_16x16x32_bf16 v[30:33], v[86:89], v[106:109], v[30:33]
    ds_read_b64_tr_b16 v[82:83], v20 offset:31520
    v_mfma_f32_16x16x32_bf16 v[50:53], v[86:89], v[110:113], v[50:53]
    ds_read_b64_tr_b16 v[84:85], v20 offset:31776
    s_waitcnt lgkmcnt(7)
    v_mfma_f32_16x16x32_bf16 v[34:37], v[66:69], v[106:109], v[34:37]
    ds_read_b64_tr_b16 v[86:87], v20 offset:31552
    v_mfma_f32_16x16x32_bf16 v[54:57], v[66:69], v[110:113], v[54:57]
    ds_read_b64_tr_b16 v[88:89], v20 offset:31808
    s_waitcnt lgkmcnt(7)
    v_mfma_f32_16x16x32_bf16 v[38:41], v[70:73], v[106:109], v[38:41]
    ds_read_b64_tr_b16 v[66:67], v20 offset:31584
    v_mfma_f32_16x16x32_bf16 v[58:61], v[70:73], v[110:113], v[58:61]
    ds_read_b64_tr_b16 v[68:69], v20 offset:31840
    s_waitcnt lgkmcnt(8)
    v_mfma_f32_16x16x32_bf16 v[42:45], v[74:77], v[106:109], v[42:45]
    ds_read_b128 v[70:73], v21 offset:39936
    v_mfma_f32_16x16x32_bf16 v[62:65], v[74:77], v[110:113], v[62:65]
    s_waitcnt vmcnt(12) lgkmcnt(7)
    v_mfma_f32_16x16x32_bf16 v[26:29], v[78:81], v[114:117], v[26:29]
    v_add_u32 v20, 0x16680, v20
    v_add_u32 v21, 0x16680, v21
    ds_read_b64_tr_b16 v[74:75], v20 offset:0
    v_mfma_f32_16x16x32_bf16 v[46:49], v[78:81], v[118:121], v[46:49]
    ds_read_b64_tr_b16 v[76:77], v20 offset:256
    s_waitcnt lgkmcnt(7)
    v_mfma_f32_16x16x32_bf16 v[30:33], v[82:85], v[114:117], v[30:33]
    ds_read_b64_tr_b16 v[78:79], v20 offset:32
    v_mfma_f32_16x16x32_bf16 v[50:53], v[82:85], v[118:121], v[50:53]
    ds_read_b64_tr_b16 v[80:81], v20 offset:288
    s_waitcnt lgkmcnt(7)
    v_mfma_f32_16x16x32_bf16 v[34:37], v[86:89], v[114:117], v[34:37]
    ds_read_b64_tr_b16 v[82:83], v20 offset:64
    v_mfma_f32_16x16x32_bf16 v[54:57], v[86:89], v[118:121], v[54:57]
    ds_read_b64_tr_b16 v[84:85], v20 offset:320
    s_waitcnt lgkmcnt(7)
    v_mfma_f32_16x16x32_bf16 v[38:41], v[66:69], v[114:117], v[38:41]
    ds_read_b64_tr_b16 v[86:87], v20 offset:96
    v_mfma_f32_16x16x32_bf16 v[58:61], v[66:69], v[118:121], v[58:61]
    ds_read_b64_tr_b16 v[88:89], v20 offset:352
    s_waitcnt lgkmcnt(8)
    v_mfma_f32_16x16x32_bf16 v[42:45], v[70:73], v[114:117], v[42:45]
    ds_read_b128 v[66:69], v21 offset:8448
    v_mfma_f32_16x16x32_bf16 v[62:65], v[70:73], v[118:121], v[62:65]
    s_waitcnt vmcnt(10) lgkmcnt(7)
    v_mfma_f32_16x16x32_bf16 v[26:29], v[74:77], v[122:125], v[26:29]
    ds_read_b64_tr_b16 v[70:71], v20 offset:10496
    v_mfma_f32_16x16x32_bf16 v[46:49], v[74:77], v[126:129], v[46:49]
    ds_read_b64_tr_b16 v[72:73], v20 offset:10752
    s_waitcnt lgkmcnt(7)
    v_mfma_f32_16x16x32_bf16 v[30:33], v[78:81], v[122:125], v[30:33]
    ds_read_b64_tr_b16 v[74:75], v20 offset:10528
    v_mfma_f32_16x16x32_bf16 v[50:53], v[78:81], v[126:129], v[50:53]
    ds_read_b64_tr_b16 v[76:77], v20 offset:10784
    s_waitcnt lgkmcnt(7)
    v_mfma_f32_16x16x32_bf16 v[34:37], v[82:85], v[122:125], v[34:37]
    ds_read_b64_tr_b16 v[78:79], v20 offset:10560
    v_mfma_f32_16x16x32_bf16 v[54:57], v[82:85], v[126:129], v[54:57]
    ds_read_b64_tr_b16 v[80:81], v20 offset:10816
    s_waitcnt lgkmcnt(7)
    v_mfma_f32_16x16x32_bf16 v[38:41], v[86:89], v[122:125], v[38:41]
    ds_read_b64_tr_b16 v[82:83], v20 offset:10592
    v_mfma_f32_16x16x32_bf16 v[58:61], v[86:89], v[126:129], v[58:61]
    ds_read_b64_tr_b16 v[84:85], v20 offset:10848
    s_waitcnt lgkmcnt(8)
    v_mfma_f32_16x16x32_bf16 v[42:45], v[66:69], v[122:125], v[42:45]
    ds_read_b128 v[86:89], v21 offset:18944
    v_mfma_f32_16x16x32_bf16 v[62:65], v[66:69], v[126:129], v[62:65]
    s_waitcnt vmcnt(8) lgkmcnt(7)
    v_mfma_f32_16x16x32_bf16 v[26:29], v[70:73], v[130:133], v[26:29]
    v_add_u32 v20, 0xfffded80, v20
    v_add_u32 v21, 0xfffded80, v21
    ds_read_b64_tr_b16 v[66:67], v20 offset:0
    v_mfma_f32_16x16x32_bf16 v[46:49], v[70:73], v[134:137], v[46:49]
    ds_read_b64_tr_b16 v[68:69], v20 offset:256
    s_waitcnt lgkmcnt(7)
    v_mfma_f32_16x16x32_bf16 v[30:33], v[74:77], v[130:133], v[30:33]
    ds_read_b64_tr_b16 v[70:71], v20 offset:32
    v_mfma_f32_16x16x32_bf16 v[50:53], v[74:77], v[134:137], v[50:53]
    ds_read_b64_tr_b16 v[72:73], v20 offset:288
    s_waitcnt lgkmcnt(7)
    v_mfma_f32_16x16x32_bf16 v[34:37], v[78:81], v[130:133], v[34:37]
    ds_read_b64_tr_b16 v[74:75], v20 offset:64
    v_mfma_f32_16x16x32_bf16 v[54:57], v[78:81], v[134:137], v[54:57]
    ds_read_b64_tr_b16 v[76:77], v20 offset:320
    s_waitcnt lgkmcnt(7)
    v_mfma_f32_16x16x32_bf16 v[38:41], v[82:85], v[130:133], v[38:41]
    ds_read_b64_tr_b16 v[78:79], v20 offset:96
    v_mfma_f32_16x16x32_bf16 v[58:61], v[82:85], v[134:137], v[58:61]
    ds_read_b64_tr_b16 v[80:81], v20 offset:352
    s_waitcnt lgkmcnt(8)
    v_mfma_f32_16x16x32_bf16 v[42:45], v[86:89], v[130:133], v[42:45]
    ds_read_b128 v[82:85], v21 offset:8448
    v_mfma_f32_16x16x32_bf16 v[62:65], v[86:89], v[134:137], v[62:65]
    s_waitcnt vmcnt(6) lgkmcnt(7)
    v_mfma_f32_16x16x32_bf16 v[26:29], v[66:69], v[138:141], v[26:29]
    ds_read_b64_tr_b16 v[86:87], v20 offset:10496
    v_mfma_f32_16x16x32_bf16 v[46:49], v[66:69], v[142:145], v[46:49]
    ds_read_b64_tr_b16 v[88:89], v20 offset:10752
    s_waitcnt lgkmcnt(7)
    v_mfma_f32_16x16x32_bf16 v[30:33], v[70:73], v[138:141], v[30:33]
    ds_read_b64_tr_b16 v[66:67], v20 offset:10528
    v_mfma_f32_16x16x32_bf16 v[50:53], v[70:73], v[142:145], v[50:53]
    ds_read_b64_tr_b16 v[68:69], v20 offset:10784
    s_waitcnt lgkmcnt(7)
    v_mfma_f32_16x16x32_bf16 v[34:37], v[74:77], v[138:141], v[34:37]
    ds_read_b64_tr_b16 v[70:71], v20 offset:10560
    v_mfma_f32_16x16x32_bf16 v[54:57], v[74:77], v[142:145], v[54:57]
    ds_read_b64_tr_b16 v[72:73], v20 offset:10816
    s_waitcnt lgkmcnt(7)
    v_mfma_f32_16x16x32_bf16 v[38:41], v[78:81], v[138:141], v[38:41]
    ds_read_b64_tr_b16 v[74:75], v20 offset:10592
    v_mfma_f32_16x16x32_bf16 v[58:61], v[78:81], v[142:145], v[58:61]
    ds_read_b64_tr_b16 v[76:77], v20 offset:10848
    s_waitcnt lgkmcnt(8)
    v_mfma_f32_16x16x32_bf16 v[42:45], v[82:85], v[138:141], v[42:45]
    ds_read_b128 v[78:81], v21 offset:18944
    v_mfma_f32_16x16x32_bf16 v[62:65], v[82:85], v[142:145], v[62:65]
    s_waitcnt vmcnt(4) lgkmcnt(7)
    v_mfma_f32_16x16x32_bf16 v[26:29], v[86:89], v[146:149], v[26:29]
    ds_read_b64_tr_b16 v[82:83], v20 offset:20992
    v_mfma_f32_16x16x32_bf16 v[46:49], v[86:89], v[150:153], v[46:49]
    ds_read_b64_tr_b16 v[84:85], v20 offset:21248
    s_waitcnt lgkmcnt(7)
    v_mfma_f32_16x16x32_bf16 v[30:33], v[66:69], v[146:149], v[30:33]
    ds_read_b64_tr_b16 v[86:87], v20 offset:21024
    v_mfma_f32_16x16x32_bf16 v[50:53], v[66:69], v[150:153], v[50:53]
    ds_read_b64_tr_b16 v[88:89], v20 offset:21280
    s_waitcnt lgkmcnt(7)
    v_mfma_f32_16x16x32_bf16 v[34:37], v[70:73], v[146:149], v[34:37]
    ds_read_b64_tr_b16 v[66:67], v20 offset:21056
    v_mfma_f32_16x16x32_bf16 v[54:57], v[70:73], v[150:153], v[54:57]
    ds_read_b64_tr_b16 v[68:69], v20 offset:21312
    s_waitcnt lgkmcnt(7)
    v_mfma_f32_16x16x32_bf16 v[38:41], v[74:77], v[146:149], v[38:41]
    ds_read_b64_tr_b16 v[70:71], v20 offset:21088
    v_mfma_f32_16x16x32_bf16 v[58:61], v[74:77], v[150:153], v[58:61]
    ds_read_b64_tr_b16 v[72:73], v20 offset:21344
    s_waitcnt lgkmcnt(8)
    v_mfma_f32_16x16x32_bf16 v[42:45], v[78:81], v[146:149], v[42:45]
    ds_read_b128 v[74:77], v21 offset:29440
    v_mfma_f32_16x16x32_bf16 v[62:65], v[78:81], v[150:153], v[62:65]
    s_waitcnt vmcnt(2) lgkmcnt(7)
    v_mfma_f32_16x16x32_bf16 v[26:29], v[82:85], v[90:93], v[26:29]
    ds_read_b64_tr_b16 v[78:79], v20 offset:31488
    v_mfma_f32_16x16x32_bf16 v[46:49], v[82:85], v[94:97], v[46:49]
    ds_read_b64_tr_b16 v[80:81], v20 offset:31744
    s_waitcnt lgkmcnt(7)
    v_mfma_f32_16x16x32_bf16 v[30:33], v[86:89], v[90:93], v[30:33]
    ds_read_b64_tr_b16 v[82:83], v20 offset:31520
    v_mfma_f32_16x16x32_bf16 v[50:53], v[86:89], v[94:97], v[50:53]
    ds_read_b64_tr_b16 v[84:85], v20 offset:31776
    s_waitcnt lgkmcnt(7)
    v_mfma_f32_16x16x32_bf16 v[34:37], v[66:69], v[90:93], v[34:37]
    ds_read_b64_tr_b16 v[86:87], v20 offset:31552
    v_mfma_f32_16x16x32_bf16 v[54:57], v[66:69], v[94:97], v[54:57]
    ds_read_b64_tr_b16 v[88:89], v20 offset:31808
    s_waitcnt lgkmcnt(7)
    v_mfma_f32_16x16x32_bf16 v[38:41], v[70:73], v[90:93], v[38:41]
    ds_read_b64_tr_b16 v[66:67], v20 offset:31584
    v_mfma_f32_16x16x32_bf16 v[58:61], v[70:73], v[94:97], v[58:61]
    ds_read_b64_tr_b16 v[68:69], v20 offset:31840
    s_waitcnt lgkmcnt(8)
    v_mfma_f32_16x16x32_bf16 v[42:45], v[74:77], v[90:93], v[42:45]
    ds_read_b128 v[70:73], v21 offset:39936
    v_mfma_f32_16x16x32_bf16 v[62:65], v[74:77], v[94:97], v[62:65]
    s_waitcnt vmcnt(0) lgkmcnt(7)
    v_mfma_f32_16x16x32_bf16 v[46:49], v[78:81], v[102:105], v[46:49]
    s_waitcnt lgkmcnt(5)
    v_mfma_f32_16x16x32_bf16 v[50:53], v[82:85], v[102:105], v[50:53]
    s_waitcnt lgkmcnt(3)
    v_mfma_f32_16x16x32_bf16 v[54:57], v[86:89], v[102:105], v[54:57]
    s_waitcnt lgkmcnt(1)
    v_mfma_f32_16x16x32_bf16 v[58:61], v[66:69], v[102:105], v[58:61]
    s_waitcnt lgkmcnt(0)
    v_mfma_f32_16x16x32_bf16 v[62:65], v[70:73], v[102:105], v[62:65]
    v_mfma_f32_16x16x32_bf16 v[26:29], v[78:81], v[98:101], v[26:29]
    ds_write_b128 v23, v[46:49] offset:0
    v_mfma_f32_16x16x32_bf16 v[30:33], v[82:85], v[98:101], v[30:33]
    ds_write_b128 v23, v[50:53] offset:1024
    v_mfma_f32_16x16x32_bf16 v[34:37], v[86:89], v[98:101], v[34:37]
    ds_write_b128 v23, v[54:57] offset:2048
    v_mfma_f32_16x16x32_bf16 v[38:41], v[66:69], v[98:101], v[38:41]
    ds_write_b128 v23, v[58:61] offset:3072
    v_mfma_f32_16x16x32_bf16 v[42:45], v[70:73], v[98:101], v[42:45]
    ds_write_b128 v23, v[62:65] offset:4096
    v_mov_b32 v90, 0x3f803f80
    v_mov_b32 v91, 0x3f803f80
    v_mov_b32 v92, 0x3f803f80
    v_mov_b32 v93, 0x3f803f80
    s_bitcmp1_b32 s38, 0
    s_movk_i32 s52, 5120
    s_cmovk_i32 s52, 60416
    v_add_u32 v14, s52, v23
    s_waitcnt lgkmcnt(0)
    s_barrier
    ds_read_b128 v[46:49], v14 offset:0
    ds_read_b128 v[50:53], v14 offset:1024
    ds_read_b128 v[54:57], v14 offset:2048
    ds_read_b128 v[58:61], v14 offset:3072
    ds_read_b128 v[62:65], v14 offset:4096
    s_waitcnt lgkmcnt(4)
    v_pk_add_f32 v[26:27], v[26:27], v[46:47]
    v_pk_add_f32 v[28:29], v[28:29], v[48:49]
    v_cvt_pk_bf16_f32 v2, v26, v27
    v_cvt_pk_bf16_f32 v3, v28, v29
    s_waitcnt lgkmcnt(3)
    v_pk_add_f32 v[30:31], v[30:31], v[50:51]
    v_pk_add_f32 v[32:33], v[32:33], v[52:53]
    v_cvt_pk_bf16_f32 v4, v30, v31
    v_cvt_pk_bf16_f32 v5, v32, v33
    s_nop 0
    v_permlane16_swap_b32 v2, v4
    v_permlane16_swap_b32 v3, v5
    buffer_store_dwordx4 v[2:5], v18, s[4:7], s75 offen offset:0 sc1
    s_nop 0
    v_mfma_f32_16x16x32_bf16 v[66:69], v[2:5], v[2:5], 0
    v_mfma_f32_16x16x32_bf16 v[70:73], v[90:93], v[2:5], 0
    s_waitcnt lgkmcnt(2)
    v_pk_add_f32 v[34:35], v[34:35], v[54:55]
    v_pk_add_f32 v[36:37], v[36:37], v[56:57]
    v_cvt_pk_bf16_f32 v6, v34, v35
    v_cvt_pk_bf16_f32 v7, v36, v37
    s_waitcnt lgkmcnt(1)
    v_pk_add_f32 v[38:39], v[38:39], v[58:59]
    v_pk_add_f32 v[40:41], v[40:41], v[60:61]
    v_cvt_pk_bf16_f32 v8, v38, v39
    v_cvt_pk_bf16_f32 v9, v40, v41
    s_nop 0
    v_permlane16_swap_b32 v6, v8
    v_permlane16_swap_b32 v7, v9
    buffer_store_dwordx4 v[6:9], v18, s[4:7], s75 offen offset:1024 sc1
    s_nop 0
    v_mfma_f32_16x16x32_bf16 v[66:69], v[6:9], v[6:9], v[66:69]
    v_mfma_f32_16x16x32_bf16 v[70:73], v[90:93], v[6:9], v[70:73]
    s_waitcnt lgkmcnt(0)
    v_pk_add_f32 v[42:43], v[42:43], v[62:63]
    v_pk_add_f32 v[44:45], v[44:45], v[64:65]
    v_cvt_pk_bf16_f32 v10, v42, v43
    v_cvt_pk_bf16_f32 v11, v44, v45
    buffer_store_dwordx2 v[10:11], v19, s[4:7], s76 offen sc1
    s_nop 0
    v_mfma_f32_16x16x32_bf16 v[66:69], v[10:13], v[10:13], v[66:69]
    v_mfma_f32_16x16x32_bf16 v[70:73], v[90:93], v[10:13], v[70:73]
    v_lshlrev_b32 v15, 1, v22
    s_mov_b32 exec_lo, 0x00f0000f
    s_mov_b32 exec_hi, 0xf0000f00
    s_nop 3
    v_cndmask_b32 v66, v66, v67, s[88:89]
    v_cndmask_b32 v66, v66, v68, s[90:91]
    v_cndmask_b32 v71, v66, v69, s[92:93]
    buffer_store_dwordx2 v[70:71], v15, s[4:7], s77 offen sc1
    s_mov_b64 exec, -1
    v_bfe_u32 v14, v0, 2, 2
    v_lshrrev_b32 v16, 5, v0
    v_lshl_add_u32 v14, v16, 3, v14
    v_bfe_u32 v17, v0, 4, 1
    v_and_b32 v165, 3, v0
    v_lshlrev_b32 v165, 3, v165
    v_lshl_add_u32 v165, v17, 5, v165
    v_lshl_add_u32 v164, v14, 6, v165
    v_lshl_add_u32 v163, v14, 7, v165
    v_bfe_u32 v14, v0, 3, 1
    v_lshl_add_u32 v162, v14, 6, v163
    v_xor_b32 v163, 64, v162
    v_lshl_add_u32 v15, v16, 9, v15
    v_lshl_add_u32 v15, v17, 10, v15
    v_mul_u32_u24 v17, 20480, v17
    v_lshl_add_u32 v17, v16, 8, v17
    v_lshl_add_u32 v165, v22, 2, v17
    v_mov_b32 v14, s45
    s_mov_b64 exec, 1
    s_waitcnt vmcnt(0)
    s_cmp_eq_u32 s46, 0
    s_cbranch_scc1 .slow_69
    buffer_store_dword v14, off, s[4:7], s78
.join_70:
    s_mov_b64 exec, -1
    s_mov_b32 s47, 65536
.poll_71:
    buffer_load_dword v14, v22, s[4:7], s79 offen sc1
    s_sub_u32 s47, s47, 1
    s_cbranch_scc1 .polld_72
    s_waitcnt vmcnt(0)
    v_cmp_ne_u32 vcc, s45, v14
    s_cmp_lg_u64 vcc, 0
    s_cbranch_scc1 .poll_71
.polld_72:
    buffer_load_dwordx4 v[98:101], v165, s[4:7], s81 offen offset:0 sc1
    buffer_load_dwordx4 v[102:105], v165, s[4:7], s81 offen offset:512 sc1
    buffer_load_dwordx4 v[106:109], v165, s[4:7], s81 offen offset:1024 sc1
    buffer_load_dwordx4 v[110:113], v165, s[4:7], s81 offen offset:1536 sc1
    buffer_load_dwordx2 v[154:155], v15, s[4:7], s80 offen offset:0 sc1
    buffer_load_dwordx2 v[156:157], v15, s[4:7], s80 offen offset:128 sc1
    buffer_load_dwordx2 v[158:159], v15, s[4:7], s80 offen offset:256 sc1
    buffer_load_dwordx2 v[160:161], v15, s[4:7], s80 offen offset:384 sc1
    s_add_u32 s81, s81, 2048
    buffer_load_dwordx4 v[114:117], v165, s[4:7], s81 offen offset:0 sc1
    buffer_load_dwordx4 v[118:121], v165, s[4:7], s81 offen offset:512 sc1
    buffer_load_dwordx4 v[122:125], v165, s[4:7], s81 offen offset:1024 sc1
    buffer_load_dwordx4 v[126:129], v165, s[4:7], s81 offen offset:1536 sc1
    s_add_u32 s81, s81, 2048
    buffer_load_dwordx4 v[130:133], v165, s[4:7], s81 offen offset:0 sc1
    buffer_load_dwordx4 v[134:137], v165, s[4:7], s81 offen offset:512 sc1
    buffer_load_dwordx4 v[138:141], v165, s[4:7], s81 offen offset:1024 sc1
    buffer_load_dwordx4 v[142:145], v165, s[4:7], s81 offen offset:1536 sc1
    s_add_u32 s81, s81, 2048
    buffer_load_dwordx4 v[146:149], v165, s[4:7], s81 offen offset:0 sc1
    buffer_load_dwordx4 v[150:153], v165, s[4:7], s81 offen offset:512 sc1
    s_barrier
    ds_read_b64_tr_b16 v[74:75], v162 offset:0
    ds_read_b64_tr_b16 v[76:77], v162 offset:512
    ds_read_b64_tr_b16 v[78:79], v163 offset:0
    ds_read_b64_tr_b16 v[80:81], v163 offset:512
    ds_read_b64_tr_b16 v[82:83], v164 offset:8192
    ds_read_b64_tr_b16 v[84:85], v164 offset:8448
    ds_read_b64_tr_b16 v[86:87], v162 offset:2048
    ds_read_b64_tr_b16 v[88:89], v162 offset:2560
    ds_read_b64_tr_b16 v[90:91], v163 offset:2048
    ds_read_b64_tr_b16 v[92:93], v163 offset:2560
    s_waitcnt vmcnt(17) lgkmcnt(8)
    v_mfma_f32_32x32x16_bf16 v[26:41], v[74:77], v[98:101], 0
    ds_read_b64_tr_b16 v[94:95], v164 offset:9216
    ds_read_b64_tr_b16 v[96:97], v164 offset:9472
    s_waitcnt lgkmcnt(8)
    v_mfma_f32_32x32x16_bf16 v[42:57], v[78:81], v[98:101], 0
    ds_read_b64_tr_b16 v[74:75], v162 offset:4096
    ds_read_b64_tr_b16 v[76:77], v162 offset:4608
    s_waitcnt lgkmcnt(8)
    v_mfma_f32_32x32x16_bf16 v[58:73], v[82:85], v[98:101], 0
    ds_read_b64_tr_b16 v[78:79], v163 offset:4096
    ds_read_b64_tr_b16 v[80:81], v163 offset:4608
    s_waitcnt vmcnt(16) lgkmcnt(8)
    v_mfma_f32_32x32x16_bf16 v[26:41], v[86:89], v[102:105], v[26:41]
    ds_read_b64_tr_b16 v[82:83], v164 offset:10240
    ds_read_b64_tr_b16 v[84:85], v164 offset:10496
    s_waitcnt lgkmcnt(8)
    v_mfma_f32_32x32x16_bf16 v[42:57], v[90:93], v[102:105], v[42:57]
    ds_read_b64_tr_b16 v[86:87], v162 offset:6144
    ds_read_b64_tr_b16 v[88:89], v162 offset:6656
    s_waitcnt lgkmcnt(8)
    v_mfma_f32_32x32x16_bf16 v[58:73], v[94:97], v[102:105], v[58:73]
    ds_read_b64_tr_b16 v[90:91], v163 offset:6144
    ds_read_b64_tr_b16 v[92:93], v163 offset:6656
    s_waitcnt vmcnt(15) lgkmcnt(8)
    v_mfma_f32_32x32x16_bf16 v[26:41], v[74:77], v[106:109], v[26:41]
    ds_read_b64_tr_b16 v[94:95], v164 offset:11264
    ds_read_b64_tr_b16 v[96:97], v164 offset:11520
    s_waitcnt lgkmcnt(8)
    v_mfma_f32_32x32x16_bf16 v[42:57], v[78:81], v[106:109], v[42:57]
    ds_read_b64_tr_b16 v[74:75], v162 offset:12288
    ds_read_b64_tr_b16 v[76:77], v162 offset:12800
    s_waitcnt lgkmcnt(8)
    v_mfma_f32_32x32x16_bf16 v[58:73], v[82:85], v[106:109], v[58:73]
    ds_read_b64_tr_b16 v[78:79], v163 offset:12288
    ds_read_b64_tr_b16 v[80:81], v163 offset:12800
    s_waitcnt vmcnt(14) lgkmcnt(8)
    v_mfma_f32_32x32x16_bf16 v[26:41], v[86:89], v[110:113], v[26:41]
    ds_read_b64_tr_b16 v[82:83], v164 offset:20480
    ds_read_b64_tr_b16 v[84:85], v164 offset:20736
    s_waitcnt lgkmcnt(8)
    v_mfma_f32_32x32x16_bf16 v[42:57], v[90:93], v[110:113], v[42:57]
    ds_read_b64_tr_b16 v[86:87], v162 offset:14336
    ds_read_b64_tr_b16 v[88:89], v162 offset:14848
    s_waitcnt lgkmcnt(8)
    v_mfma_f32_32x32x16_bf16 v[58:73], v[94:97], v[110:113], v[58:73]
    ds_read_b64_tr_b16 v[90:91], v163 offset:14336
    ds_read_b64_tr_b16 v[92:93], v163 offset:14848
    s_waitcnt vmcnt(9) lgkmcnt(8)
    v_mfma_f32_32x32x16_bf16 v[26:41], v[74:77], v[114:117], v[26:41]
    ds_read_b64_tr_b16 v[94:95], v164 offset:21504
    ds_read_b64_tr_b16 v[96:97], v164 offset:21760
    s_waitcnt lgkmcnt(8)
    v_mfma_f32_32x32x16_bf16 v[42:57], v[78:81], v[114:117], v[42:57]
    ds_read_b64_tr_b16 v[74:75], v162 offset:16384
    ds_read_b64_tr_b16 v[76:77], v162 offset:16896
    v_add_f32 v16, v154, v156
    v_add_f32 v14, v158, v160
    v_add_f32 v17, v155, v157
    v_add_f32 v15, v159, v161
    buffer_load_dwordx4 v[154:157], v165, s[4:7], s81 offen offset:1024 sc1
    buffer_load_dwordx4 v[158:161], v165, s[4:7], s81 offen offset:1536 sc1
    s_add_u32 s81, s81, 2048
    buffer_load_dwordx4 v[98:101], v165, s[4:7], s81 offen offset:0 sc1
    buffer_load_dwordx4 v[102:105], v165, s[4:7], s81 offen offset:512 sc1
    buffer_load_dwordx4 v[106:109], v165, s[4:7], s81 offen offset:1024 sc1
    buffer_load_dwordx4 v[110:113], v165, s[4:7], s81 offen offset:1536 sc1
    s_waitcnt lgkmcnt(8)
    v_mfma_f32_32x32x16_bf16 v[58:73], v[82:85], v[114:117], v[58:73]
    ds_read_b64_tr_b16 v[78:79], v163 offset:16384
    ds_read_b64_tr_b16 v[80:81], v163 offset:16896
    s_add_u32 s81, s81, s87
    buffer_load_dwordx4 v[114:117], v165, s[4:7], s81 offen offset:0 sc1
    s_waitcnt vmcnt(15) lgkmcnt(8)
    v_mfma_f32_32x32x16_bf16 v[26:41], v[86:89], v[118:121], v[26:41]
    ds_read_b64_tr_b16 v[82:83], v164 offset:22528
    ds_read_b64_tr_b16 v[84:85], v164 offset:22784
    s_waitcnt lgkmcnt(8)
    v_mfma_f32_32x32x16_bf16 v[42:57], v[90:93], v[118:121], v[42:57]
    ds_read_b64_tr_b16 v[86:87], v162 offset:18432
    ds_read_b64_tr_b16 v[88:89], v162 offset:18944
    s_waitcnt lgkmcnt(8)
    v_mfma_f32_32x32x16_bf16 v[58:73], v[94:97], v[118:121], v[58:73]
    ds_read_b64_tr_b16 v[90:91], v163 offset:18432
    ds_read_b64_tr_b16 v[92:93], v163 offset:18944
    v_add_f32 v16, v16, v14
    buffer_load_dwordx4 v[118:121], v165, s[4:7], s81 offen offset:512 sc1
    s_waitcnt vmcnt(15) lgkmcnt(8)
    v_mfma_f32_32x32x16_bf16 v[26:41], v[74:77], v[122:125], v[26:41]
    ds_read_b64_tr_b16 v[94:95], v164 offset:23552
    ds_read_b64_tr_b16 v[96:97], v164 offset:23808
    v_add_f32 v17, v17, v15
    s_waitcnt lgkmcnt(8)
    v_mfma_f32_32x32x16_bf16 v[42:57], v[78:81], v[122:125], v[42:57]
    ds_read_b64_tr_b16 v[74:75], v162 offset:24576
    ds_read_b64_tr_b16 v[76:77], v162 offset:25088
    v_mov_b32 v14, v16
    s_waitcnt lgkmcnt(8)
    v_mfma_f32_32x32x16_bf16 v[58:73], v[82:85], v[122:125], v[58:73]
    ds_read_b64_tr_b16 v[78:79], v163 offset:24576
    ds_read_b64_tr_b16 v[80:81], v163 offset:25088
    v_mov_b32 v15, v17
    buffer_load_dwordx4 v[122:125], v165, s[4:7], s81 offen offset:1024 sc1
    s_waitcnt vmcnt(15) lgkmcnt(8)
    v_mfma_f32_32x32x16_bf16 v[26:41], v[86:89], v[126:129], v[26:41]
    ds_read_b64_tr_b16 v[82:83], v164 offset:32768
    ds_read_b64_tr_b16 v[84:85], v164 offset:33024
    v_permlane32_swap_b32 v16, v14
    s_waitcnt lgkmcnt(8)
    v_mfma_f32_32x32x16_bf16 v[42:57], v[90:93], v[126:129], v[42:57]
    ds_read_b64_tr_b16 v[86:87], v162 offset:26624
    ds_read_b64_tr_b16 v[88:89], v162 offset:27136
    v_permlane32_swap_b32 v17, v15
    s_waitcnt lgkmcnt(8)
    v_mfma_f32_32x32x16_bf16 v[58:73], v[94:97], v[126:129], v[58:73]
    ds_read_b64_tr_b16 v[90:91], v163 offset:26624
    ds_read_b64_tr_b16 v[92:93], v163 offset:27136
    v_add_f32 v16, v16, v14
    buffer_load_dwordx4 v[126:129], v165, s[4:7], s81 offen offset:1536 sc1
    s_waitcnt vmcnt(15) lgkmcnt(8)
    v_mfma_f32_32x32x16_bf16 v[26:41], v[74:77], v[130:133], v[26:41]
    ds_read_b64_tr_b16 v[94:95], v164 offset:33792
    ds_read_b64_tr_b16 v[96:97], v164 offset:34048
    v_add_f32 v17, v17, v15
    s_waitcnt lgkmcnt(8)
    v_mfma_f32_32x32x16_bf16 v[42:57], v[78:81], v[130:133], v[42:57]
    ds_read_b64_tr_b16 v[74:75], v162 offset:28672
    ds_read_b64_tr_b16 v[76:77], v162 offset:29184
    v_mul_f32 v16, 0x3acccccd, v16
    s_waitcnt lgkmcnt(8)
    v_mfma_f32_32x32x16_bf16 v[58:73], v[82:85], v[130:133], v[58:73]
    ds_read_b64_tr_b16 v[78:79], v163 offset:28672
    ds_read_b64_tr_b16 v[80:81], v163 offset:29184
    v_mul_f32 v17, 0x3acccccd, v17
    s_add_u32 s81, s81, 2048
    buffer_load_dwordx4 v[130:133], v165, s[4:7], s81 offen offset:0 sc1
    s_waitcnt vmcnt(15) lgkmcnt(8)
    v_mfma_f32_32x32x16_bf16 v[26:41], v[86:89], v[134:137], v[26:41]
    ds_read_b64_tr_b16 v[82:83], v164 offset:34816
    ds_read_b64_tr_b16 v[84:85], v164 offset:35072
    v_fma_f32 v17, -v16, v16, v17
    s_waitcnt lgkmcnt(8)
    v_mfma_f32_32x32x16_bf16 v[42:57], v[90:93], v[134:137], v[42:57]
    ds_read_b64_tr_b16 v[86:87], v162 offset:30720
    ds_read_b64_tr_b16 v[88:89], v162 offset:31232
    v_max_f32 v17, 0, v17
    s_waitcnt lgkmcnt(8)
    v_mfma_f32_32x32x16_bf16 v[58:73], v[94:97], v[134:137], v[58:73]
    ds_read_b64_tr_b16 v[90:91], v163 offset:30720
    ds_read_b64_tr_b16 v[92:93], v163 offset:31232
    v_cvt_pk_bf16_f32 v17, v17, v17
    buffer_load_dwordx4 v[134:137], v165, s[4:7], s81 offen offset:512 sc1
    s_waitcnt vmcnt(15) lgkmcnt(8)
    v_mfma_f32_32x32x16_bf16 v[26:41], v[74:77], v[138:141], v[26:41]
    ds_read_b64_tr_b16 v[94:95], v164 offset:35840
    ds_read_b64_tr_b16 v[96:97], v164 offset:36096
    v_lshlrev_b32 v17, 16, v17
    s_waitcnt lgkmcnt(8)
    v_mfma_f32_32x32x16_bf16 v[42:57], v[78:81], v[138:141], v[42:57]
    ds_read_b64_tr_b16 v[74:75], v162 offset:36864
    ds_read_b64_tr_b16 v[76:77], v162 offset:37376
    v_add_f32 v17, 0x3727C5AC, v17
    s_waitcnt lgkmcnt(8)
    v_mfma_f32_32x32x16_bf16 v[58:73], v[82:85], v[138:141], v[58:73]
    ds_read_b64_tr_b16 v[78:79], v163 offset:36864
    ds_read_b64_tr_b16 v[80:81], v163 offset:37376
    v_cvt_pk_bf16_f32 v17, v17, v17
    buffer_load_dwordx4 v[138:141], v165, s[4:7], s81 offen offset:1024 sc1
    s_waitcnt vmcnt(15) lgkmcnt(8)
    v_mfma_f32_32x32x16_bf16 v[26:41], v[86:89], v[142:145], v[26:41]
    ds_read_b64_tr_b16 v[82:83], v164 offset:45056
    ds_read_b64_tr_b16 v[84:85], v164 offset:45312
    v_lshlrev_b32 v17, 16, v17
    s_waitcnt lgkmcnt(8)
    v_mfma_f32_32x32x16_bf16 v[42:57], v[90:93], v[142:145], v[42:57]
    ds_read_b64_tr_b16 v[86:87], v162 offset:38912
    ds_read_b64_tr_b16 v[88:89], v162 offset:39424
    v_sqrt_f32 v17, v17
    s_waitcnt lgkmcnt(8)
    v_mfma_f32_32x32x16_bf16 v[58:73], v[94:97], v[142:145], v[58:73]
    ds_read_b64_tr_b16 v[90:91], v163 offset:38912
    ds_read_b64_tr_b16 v[92:93], v163 offset:39424
    v_cvt_pk_bf16_f32 v16, v16, v16
    buffer_load_dwordx4 v[142:145], v165, s[4:7], s81 offen offset:1536 sc1
    s_waitcnt vmcnt(15) lgkmcnt(8)
    v_mfma_f32_32x32x16_bf16 v[26:41], v[74:77], v[146:149], v[26:41]
    ds_read_b64_tr_b16 v[94:95], v164 offset:46080
    ds_read_b64_tr_b16 v[96:97], v164 offset:46336
    v_lshlrev_b32 v16, 16, v16
    s_waitcnt lgkmcnt(8)
    v_mfma_f32_32x32x16_bf16 v[42:57], v[78:81], v[146:149], v[42:57]
    ds_read_b64_tr_b16 v[74:75], v162 offset:40960
    ds_read_b64_tr_b16 v[76:77], v162 offset:41472
    v_cvt_pk_bf16_f32 v17, v17, v17
    s_waitcnt lgkmcnt(8)
    v_mfma_f32_32x32x16_bf16 v[58:73], v[82:85], v[146:149], v[58:73]
    ds_read_b64_tr_b16 v[78:79], v163 offset:40960
    ds_read_b64_tr_b16 v[80:81], v163 offset:41472
    v_lshlrev_b32 v17, 16, v17
    s_add_u32 s81, s81, 2048
    buffer_load_dwordx4 v[146:149], v165, s[4:7], s81 offen offset:0 sc1
    s_waitcnt vmcnt(15) lgkmcnt(8)
    v_mfma_f32_32x32x16_bf16 v[26:41], v[86:89], v[150:153], v[26:41]
    ds_read_b64_tr_b16 v[82:83], v164 offset:47104
    ds_read_b64_tr_b16 v[84:85], v164 offset:47360
    v_rcp_f32 v15, v17
    s_waitcnt lgkmcnt(8)
    v_mfma_f32_32x32x16_bf16 v[42:57], v[90:93], v[150:153], v[42:57]
    ds_read_b64_tr_b16 v[86:87], v162 offset:43008
    ds_read_b64_tr_b16 v[88:89], v162 offset:43520
    v_cvt_pk_bf16_f32 v17, -v16, v17
    s_waitcnt lgkmcnt(8)
    v_mfma_f32_32x32x16_bf16 v[58:73], v[94:97], v[150:153], v[58:73]
    ds_read_b64_tr_b16 v[90:91], v163 offset:43008
    ds_read_b64_tr_b16 v[92:93], v163 offset:43520
    v_cvt_pk_bf16_f32 v16, -v16, -v16
    buffer_load_dwordx4 v[150:153], v165, s[4:7], s81 offen offset:512 sc1
    s_waitcnt vmcnt(15) lgkmcnt(8)
    v_mfma_f32_32x32x16_bf16 v[26:41], v[74:77], v[154:157], v[26:41]
    ds_read_b64_tr_b16 v[94:95], v164 offset:48128
    ds_read_b64_tr_b16 v[96:97], v164 offset:48384
    v_cmp_gt_u32 vcc, 32, v0
    s_waitcnt lgkmcnt(8)
    v_mfma_f32_32x32x16_bf16 v[42:57], v[78:81], v[154:157], v[42:57]
    ds_read_b64_tr_b16 v[74:75], v162 offset:49152
    ds_read_b64_tr_b16 v[76:77], v162 offset:49664
    v_cndmask_b32 v16, 0, v16, vcc
    s_waitcnt lgkmcnt(8)
    v_mfma_f32_32x32x16_bf16 v[58:73], v[82:85], v[154:157], v[58:73]
    ds_read_b64_tr_b16 v[78:79], v163 offset:49152
    ds_read_b64_tr_b16 v[80:81], v163 offset:49664
    v_cndmask_b32 v17, 0, v17, vcc
    buffer_load_dwordx4 v[154:157], v165, s[4:7], s81 offen offset:1024 sc1
    s_waitcnt vmcnt(15) lgkmcnt(8)
    v_mfma_f32_32x32x16_bf16 v[26:41], v[86:89], v[158:161], v[26:41]
    ds_read_b64_tr_b16 v[82:83], v164 offset:57344
    ds_read_b64_tr_b16 v[84:85], v164 offset:57600
    v_and_b32 v14, 31, v0
    s_waitcnt lgkmcnt(8)
    v_mfma_f32_32x32x16_bf16 v[42:57], v[90:93], v[158:161], v[42:57]
    ds_read_b64_tr_b16 v[86:87], v162 offset:51200
    ds_read_b64_tr_b16 v[88:89], v162 offset:51712
    v_lshlrev_b32 v14, 3, v14
    s_waitcnt lgkmcnt(8)
    v_mfma_f32_32x32x16_bf16 v[58:73], v[94:97], v[158:161], v[58:73]
    ds_read_b64_tr_b16 v[90:91], v163 offset:51200
    ds_read_b64_tr_b16 v[92:93], v163 offset:51712
    v_add_u32 v14, 161792, v14
    buffer_load_dwordx4 v[158:161], v165, s[4:7], s81 offen offset:1536 sc1
    s_waitcnt vmcnt(15) lgkmcnt(8)
    v_mfma_f32_32x32x16_bf16 v[26:41], v[74:77], v[98:101], v[26:41]
    ds_read_b64_tr_b16 v[94:95], v164 offset:58368
    ds_read_b64_tr_b16 v[96:97], v164 offset:58624
    s_waitcnt lgkmcnt(8)
    v_mfma_f32_32x32x16_bf16 v[42:57], v[78:81], v[98:101], v[42:57]
    ds_read_b64_tr_b16 v[74:75], v162 offset:53248
    ds_read_b64_tr_b16 v[76:77], v162 offset:53760
    s_waitcnt lgkmcnt(8)
    v_mfma_f32_32x32x16_bf16 v[58:73], v[82:85], v[98:101], v[58:73]
    ds_read_b64_tr_b16 v[78:79], v163 offset:53248
    ds_read_b64_tr_b16 v[80:81], v163 offset:53760
    s_add_u32 s81, s81, 2048
    buffer_load_dwordx4 v[98:101], v165, s[4:7], s81 offen offset:0 sc1
    s_waitcnt vmcnt(15) lgkmcnt(8)
    v_mfma_f32_32x32x16_bf16 v[26:41], v[86:89], v[102:105], v[26:41]
    ds_read_b64_tr_b16 v[82:83], v164 offset:59392
    ds_read_b64_tr_b16 v[84:85], v164 offset:59648
    s_waitcnt lgkmcnt(8)
    v_mfma_f32_32x32x16_bf16 v[42:57], v[90:93], v[102:105], v[42:57]
    ds_read_b64_tr_b16 v[86:87], v162 offset:55296
    ds_read_b64_tr_b16 v[88:89], v162 offset:55808
    s_waitcnt lgkmcnt(8)
    v_mfma_f32_32x32x16_bf16 v[58:73], v[94:97], v[102:105], v[58:73]
    ds_read_b64_tr_b16 v[90:91], v163 offset:55296
    ds_read_b64_tr_b16 v[92:93], v163 offset:55808
    buffer_load_dwordx4 v[102:105], v165, s[4:7], s81 offen offset:512 sc1
    s_waitcnt vmcnt(15) lgkmcnt(8)
    v_mfma_f32_32x32x16_bf16 v[26:41], v[74:77], v[106:109], v[26:41]
    ds_read_b64_tr_b16 v[94:95], v164 offset:60416
    ds_read_b64_tr_b16 v[96:97], v164 offset:60672
    s_waitcnt lgkmcnt(8)
    v_mfma_f32_32x32x16_bf16 v[42:57], v[78:81], v[106:109], v[42:57]
    v_add_u32 v162, 0xf000, v162
    v_add_u32 v163, 0xf000, v163
    v_add_u32 v164, 0xf000, v164
    ds_read_b64_tr_b16 v[74:75], v162 offset:0
    ds_read_b64_tr_b16 v[76:77], v162 offset:512
    s_waitcnt lgkmcnt(8)
    v_mfma_f32_32x32x16_bf16 v[58:73], v[82:85], v[106:109], v[58:73]
    ds_read_b64_tr_b16 v[78:79], v163 offset:0
    ds_read_b64_tr_b16 v[80:81], v163 offset:512
    buffer_load_dwordx4 v[106:109], v165, s[4:7], s81 offen offset:1024 sc1
    s_waitcnt vmcnt(15) lgkmcnt(8)
    v_mfma_f32_32x32x16_bf16 v[26:41], v[86:89], v[110:113], v[26:41]
    ds_read_b64_tr_b16 v[82:83], v164 offset:8192
    ds_read_b64_tr_b16 v[84:85], v164 offset:8448
    s_waitcnt lgkmcnt(8)
    v_mfma_f32_32x32x16_bf16 v[42:57], v[90:93], v[110:113], v[42:57]
    ds_read_b64_tr_b16 v[86:87], v162 offset:2048
    ds_read_b64_tr_b16 v[88:89], v162 offset:2560
    s_waitcnt lgkmcnt(8)
    v_mfma_f32_32x32x16_bf16 v[58:73], v[94:97], v[110:113], v[58:73]
    ds_read_b64_tr_b16 v[90:91], v163 offset:2048
    ds_read_b64_tr_b16 v[92:93], v163 offset:2560
    buffer_load_dwordx4 v[110:113], v165, s[4:7], s81 offen offset:1536 sc1
    s_barrier
    s_waitcnt vmcnt(15) lgkmcnt(8)
    v_mfma_f32_32x32x16_bf16 v[26:41], v[74:77], v[114:117], v[26:41]
    ds_read_b64_tr_b16 v[94:95], v164 offset:9216
    ds_read_b64_tr_b16 v[96:97], v164 offset:9472
    s_waitcnt lgkmcnt(8)
    v_mfma_f32_32x32x16_bf16 v[42:57], v[78:81], v[114:117], v[42:57]
    ds_read_b64_tr_b16 v[74:75], v162 offset:4096
    ds_read_b64_tr_b16 v[76:77], v162 offset:4608
    s_waitcnt lgkmcnt(8)
    v_mfma_f32_32x32x16_bf16 v[58:73], v[82:85], v[114:117], v[58:73]
    ds_read_b64_tr_b16 v[78:79], v163 offset:4096
    ds_read_b64_tr_b16 v[80:81], v163 offset:4608
    s_add_u32 s81, s81, 2048
    buffer_load_dwordx4 v[114:117], v165, s[4:7], s81 offen offset:0 sc1
    s_waitcnt vmcnt(15) lgkmcnt(8)
    v_mfma_f32_32x32x16_bf16 v[26:41], v[86:89], v[118:121], v[26:41]
    ds_read_b64_tr_b16 v[82:83], v164 offset:10240
    ds_read_b64_tr_b16 v[84:85], v164 offset:10496
    s_waitcnt lgkmcnt(8)
    v_mfma_f32_32x32x16_bf16 v[42:57], v[90:93], v[118:121], v[42:57]
    ds_read_b64_tr_b16 v[86:87], v162 offset:6144
    ds_read_b64_tr_b16 v[88:89], v162 offset:6656
    s_waitcnt lgkmcnt(8)
    v_mfma_f32_32x32x16_bf16 v[58:73], v[94:97], v[118:121], v[58:73]
    ds_read_b64_tr_b16 v[90:91], v163 offset:6144
    ds_read_b64_tr_b16 v[92:93], v163 offset:6656
    buffer_load_dwordx4 v[118:121], v165, s[4:7], s81 offen offset:512 sc1
    s_waitcnt vmcnt(15) lgkmcnt(8)
    v_mfma_f32_32x32x16_bf16 v[26:41], v[74:77], v[122:125], v[26:41]
    ds_read_b64_tr_b16 v[94:95], v164 offset:11264
    ds_read_b64_tr_b16 v[96:97], v164 offset:11520
    s_waitcnt lgkmcnt(8)
    v_mfma_f32_32x32x16_bf16 v[42:57], v[78:81], v[122:125], v[42:57]
    ds_read_b64_tr_b16 v[74:75], v162 offset:12288
    ds_read_b64_tr_b16 v[76:77], v162 offset:12800
    s_waitcnt lgkmcnt(8)
    v_mfma_f32_32x32x16_bf16 v[58:73], v[82:85], v[122:125], v[58:73]
    ds_read_b64_tr_b16 v[78:79], v163 offset:12288
    ds_read_b64_tr_b16 v[80:81], v163 offset:12800
    buffer_load_dwordx4 v[122:125], v165, s[4:7], s81 offen offset:1024 sc1
    s_waitcnt vmcnt(15) lgkmcnt(8)
    v_mfma_f32_32x32x16_bf16 v[26:41], v[86:89], v[126:129], v[26:41]
    ds_read_b64_tr_b16 v[82:83], v164 offset:20480
    ds_read_b64_tr_b16 v[84:85], v164 offset:20736
    s_waitcnt lgkmcnt(8)
    v_mfma_f32_32x32x16_bf16 v[42:57], v[90:93], v[126:129], v[42:57]
    ds_read_b64_tr_b16 v[86:87], v162 offset:14336
    ds_read_b64_tr_b16 v[88:89], v162 offset:14848
    s_waitcnt lgkmcnt(8)
    v_mfma_f32_32x32x16_bf16 v[58:73], v[94:97], v[126:129], v[58:73]
    ds_read_b64_tr_b16 v[90:91], v163 offset:14336
    ds_read_b64_tr_b16 v[92:93], v163 offset:14848
    buffer_load_dwordx4 v[126:129], v165, s[4:7], s81 offen offset:1536 sc1
    s_waitcnt vmcnt(15) lgkmcnt(8)
    v_mfma_f32_32x32x16_bf16 v[26:41], v[74:77], v[130:133], v[26:41]
    ds_read_b64_tr_b16 v[94:95], v164 offset:21504
    ds_read_b64_tr_b16 v[96:97], v164 offset:21760
    s_waitcnt lgkmcnt(8)
    v_mfma_f32_32x32x16_bf16 v[42:57], v[78:81], v[130:133], v[42:57]
    ds_read_b64_tr_b16 v[74:75], v162 offset:16384
    ds_read_b64_tr_b16 v[76:77], v162 offset:16896
    s_waitcnt lgkmcnt(8)
    v_mfma_f32_32x32x16_bf16 v[58:73], v[82:85], v[130:133], v[58:73]
    ds_read_b64_tr_b16 v[78:79], v163 offset:16384
    ds_read_b64_tr_b16 v[80:81], v163 offset:16896
    s_waitcnt vmcnt(14) lgkmcnt(8)
    v_mfma_f32_32x32x16_bf16 v[26:41], v[86:89], v[134:137], v[26:41]
    ds_read_b64_tr_b16 v[82:83], v164 offset:22528
    ds_read_b64_tr_b16 v[84:85], v164 offset:22784
    s_waitcnt lgkmcnt(8)
    v_mfma_f32_32x32x16_bf16 v[42:57], v[90:93], v[134:137], v[42:57]
    ds_read_b64_tr_b16 v[86:87], v162 offset:18432
    ds_read_b64_tr_b16 v[88:89], v162 offset:18944
    s_waitcnt lgkmcnt(8)
    v_mfma_f32_32x32x16_bf16 v[58:73], v[94:97], v[134:137], v[58:73]
    ds_read_b64_tr_b16 v[90:91], v163 offset:18432
    ds_read_b64_tr_b16 v[92:93], v163 offset:18944
    s_waitcnt vmcnt(13) lgkmcnt(8)
    v_mfma_f32_32x32x16_bf16 v[26:41], v[74:77], v[138:141], v[26:41]
    ds_read_b64_tr_b16 v[94:95], v164 offset:23552
    ds_read_b64_tr_b16 v[96:97], v164 offset:23808
    s_waitcnt lgkmcnt(8)
    v_mfma_f32_32x32x16_bf16 v[42:57], v[78:81], v[138:141], v[42:57]
    v_add_u32 v162, 0xd300, v162
    v_add_u32 v163, 0xd300, v163
    v_add_u32 v164, 0xd300, v164
    ds_read_b64_tr_b16 v[74:75], v162 offset:0
    ds_read_b64_tr_b16 v[76:77], v162 offset:512
    s_waitcnt lgkmcnt(8)
    v_mfma_f32_32x32x16_bf16 v[58:73], v[82:85], v[138:141], v[58:73]
    ds_read_b64_tr_b16 v[78:79], v163 offset:0
    ds_read_b64_tr_b16 v[80:81], v163 offset:512
    s_waitcnt vmcnt(12) lgkmcnt(8)
    v_mfma_f32_32x32x16_bf16 v[26:41], v[86:89], v[142:145], v[26:41]
    ds_read_b64_tr_b16 v[82:83], v164 offset:8192
    ds_read_b64_tr_b16 v[84:85], v164 offset:8448
    s_waitcnt lgkmcnt(8)
    v_mfma_f32_32x32x16_bf16 v[42:57], v[90:93], v[142:145], v[42:57]
    ds_read_b64_tr_b16 v[86:87], v162 offset:2048
    ds_read_b64_tr_b16 v[88:89], v162 offset:2560
    s_waitcnt lgkmcnt(8)
    v_mfma_f32_32x32x16_bf16 v[58:73], v[94:97], v[142:145], v[58:73]
    ds_read_b64_tr_b16 v[90:91], v163 offset:2048
    ds_read_b64_tr_b16 v[92:93], v163 offset:2560
    s_barrier
    s_waitcnt vmcnt(11) lgkmcnt(8)
    v_mfma_f32_32x32x16_bf16 v[26:41], v[74:77], v[146:149], v[26:41]
    ds_read_b64_tr_b16 v[94:95], v164 offset:9216
    ds_read_b64_tr_b16 v[96:97], v164 offset:9472
    s_waitcnt lgkmcnt(8)
    v_mfma_f32_32x32x16_bf16 v[42:57], v[78:81], v[146:149], v[42:57]
    ds_read_b64_tr_b16 v[74:75], v162 offset:4096
    ds_read_b64_tr_b16 v[76:77], v162 offset:4608
    s_waitcnt lgkmcnt(8)
    v_mfma_f32_32x32x16_bf16 v[58:73], v[82:85], v[146:149], v[58:73]
    ds_read_b64_tr_b16 v[78:79], v163 offset:4096
    ds_read_b64_tr_b16 v[80:81], v163 offset:4608
    s_waitcnt vmcnt(10) lgkmcnt(8)
    v_mfma_f32_32x32x16_bf16 v[26:41], v[86:89], v[150:153], v[26:41]
    ds_read_b64_tr_b16 v[82:83], v164 offset:10240
    ds_read_b64_tr_b16 v[84:85], v164 offset:10496
    s_waitcnt lgkmcnt(8)
    v_mfma_f32_32x32x16_bf16 v[42:57], v[90:93], v[150:153], v[42:57]
    ds_read_b64_tr_b16 v[86:87], v162 offset:6144
    ds_read_b64_tr_b16 v[88:89], v162 offset:6656
    s_waitcnt lgkmcnt(8)
    v_mfma_f32_32x32x16_bf16 v[58:73], v[94:97], v[150:153], v[58:73]
    ds_read_b64_tr_b16 v[90:91], v162 offset:12288
    ds_read_b64_tr_b16 v[92:93], v162 offset:12800
    v_mov_b32 v130, v16
    v_mov_b32 v131, v17
    s_waitcnt vmcnt(9) lgkmcnt(8)
    v_mfma_f32_32x32x16_bf16 v[26:41], v[74:77], v[154:157], v[26:41]
    ds_read_b64_tr_b16 v[94:95], v162 offset:14336
    ds_read_b64_tr_b16 v[96:97], v162 offset:14848
    v_mov_b32 v132, 0
    v_mov_b32 v133, 0
    s_waitcnt lgkmcnt(8)
    v_mfma_f32_32x32x16_bf16 v[42:57], v[78:81], v[154:157], v[42:57]
    ds_read_b64_tr_b16 v[74:75], v162 offset:16384
    ds_read_b64_tr_b16 v[76:77], v162 offset:16896
    v_bfe_u32 v17, v0, 4, 1
    v_mul_u32_u24 v17, 28672, v17
    s_waitcnt lgkmcnt(8)
    v_mfma_f32_32x32x16_bf16 v[58:73], v[82:85], v[154:157], v[58:73]
    ds_read_b64_tr_b16 v[78:79], v162 offset:18432
    ds_read_b64_tr_b16 v[80:81], v162 offset:18944
    v_add_u32 v165, v17, v165
    s_waitcnt vmcnt(8) lgkmcnt(8)
    v_mfma_f32_32x32x16_bf16 v[26:41], v[86:89], v[158:161], v[26:41]
    ds_read_b64_tr_b16 v[82:83], v162 offset:24576
    ds_read_b64_tr_b16 v[84:85], v162 offset:25088
    s_waitcnt vmcnt(7) lgkmcnt(8)
    v_mfma_f32_32x32x16_bf16 v[26:41], v[90:93], v[98:101], v[26:41]
    ds_read_b64_tr_b16 v[86:87], v162 offset:26624
    ds_read_b64_tr_b16 v[88:89], v162 offset:27136
    s_waitcnt vmcnt(6) lgkmcnt(8)
    v_mfma_f32_32x32x16_bf16 v[26:41], v[94:97], v[102:105], v[26:41]
    ds_read_b64_tr_b16 v[90:91], v162 offset:28672
    ds_read_b64_tr_b16 v[92:93], v162 offset:29184
    s_waitcnt vmcnt(5) lgkmcnt(8)
    v_mfma_f32_32x32x16_bf16 v[26:41], v[74:77], v[106:109], v[26:41]
    ds_read_b64_tr_b16 v[94:95], v162 offset:30720
    ds_read_b64_tr_b16 v[96:97], v162 offset:31232
    s_waitcnt vmcnt(4) lgkmcnt(8)
    v_mfma_f32_32x32x16_bf16 v[26:41], v[78:81], v[110:113], v[26:41]
    ds_read_b64 v[74:75], v14 offset:0
    s_waitcnt vmcnt(3) lgkmcnt(7)
    v_mfma_f32_32x32x16_bf16 v[26:41], v[82:85], v[114:117], v[26:41]
    ds_read_b64_tr_b16 v[78:79], v163 offset:6144
    ds_read_b64_tr_b16 v[80:81], v163 offset:6656
    s_waitcnt vmcnt(2) lgkmcnt(7)
    v_mfma_f32_32x32x16_bf16 v[26:41], v[86:89], v[118:121], v[26:41]
    ds_read_b64_tr_b16 v[82:83], v163 offset:12288
    ds_read_b64_tr_b16 v[84:85], v163 offset:12800
    s_waitcnt vmcnt(1) lgkmcnt(7)
    v_mfma_f32_32x32x16_bf16 v[26:41], v[90:93], v[122:125], v[26:41]
    ds_read_b64_tr_b16 v[86:87], v163 offset:14336
    ds_read_b64_tr_b16 v[88:89], v163 offset:14848
    s_waitcnt vmcnt(0) lgkmcnt(7)
    v_mfma_f32_32x32x16_bf16 v[26:41], v[94:97], v[126:129], v[26:41]
    ds_read_b64_tr_b16 v[90:91], v163 offset:16384
    ds_read_b64_tr_b16 v[92:93], v163 offset:16896
    s_waitcnt lgkmcnt(8)
    v_mfma_f32_32x32x16_bf16 v[26:41], v[74:77], v[130:133], v[26:41]
    ds_read_b64_tr_b16 v[94:95], v163 offset:18432
    ds_read_b64_tr_b16 v[96:97], v163 offset:18944
    s_waitcnt lgkmcnt(8)
    v_mfma_f32_32x32x16_bf16 v[42:57], v[78:81], v[158:161], v[42:57]
    ds_read_b64_tr_b16 v[74:75], v163 offset:24576
    ds_read_b64_tr_b16 v[76:77], v163 offset:25088
    s_waitcnt lgkmcnt(8)
    v_mfma_f32_32x32x16_bf16 v[42:57], v[82:85], v[98:101], v[42:57]
    ds_read_b64_tr_b16 v[78:79], v163 offset:26624
    ds_read_b64_tr_b16 v[80:81], v163 offset:27136
    s_nop 1
    v_max_f32 v26, 0, v26
    v_max_f32 v27, 0, v27
    v_max_f32 v28, 0, v28
    v_max_f32 v29, 0, v29
    s_waitcnt lgkmcnt(8)
    v_mfma_f32_32x32x16_bf16 v[42:57], v[86:89], v[102:105], v[42:57]
    ds_read_b64_tr_b16 v[82:83], v163 offset:28672
    ds_read_b64_tr_b16 v[84:85], v163 offset:29184
    v_max_f32 v30, 0, v30
    v_max_f32 v31, 0, v31
    v_max_f32 v32, 0, v32
    v_max_f32 v33, 0, v33
    s_waitcnt lgkmcnt(8)
    v_mfma_f32_32x32x16_bf16 v[42:57], v[90:93], v[106:109], v[42:57]
    ds_read_b64_tr_b16 v[86:87], v163 offset:30720
    ds_read_b64_tr_b16 v[88:89], v163 offset:31232
    v_mul_f32 v26, v26, v15
    v_mul_f32 v27, v27, v15
    v_mul_f32 v28, v28, v15
    v_mul_f32 v29, v29, v15
    s_waitcnt lgkmcnt(8)
    v_mfma_f32_32x32x16_bf16 v[42:57], v[94:97], v[110:113], v[42:57]
    ds_read_b64 v[90:91], v14 offset:256
    v_mul_f32 v30, v30, v15
    v_mul_f32 v31, v31, v15
    v_mul_f32 v32, v32, v15
    v_mul_f32 v33, v33, v15
    s_waitcnt lgkmcnt(7)
    v_mfma_f32_32x32x16_bf16 v[42:57], v[74:77], v[114:117], v[42:57]
    ds_read_b64_tr_b16 v[94:95], v164 offset:11264
    ds_read_b64_tr_b16 v[96:97], v164 offset:11520
    v_mul_f32 v26, v26, v26
    v_mul_f32 v27, v27, v27
    v_mul_f32 v28, v28, v28
    v_mul_f32 v29, v29, v29
    s_waitcnt lgkmcnt(7)
    v_mfma_f32_32x32x16_bf16 v[42:57], v[78:81], v[118:121], v[42:57]
    ds_read_b64_tr_b16 v[74:75], v164 offset:20480
    ds_read_b64_tr_b16 v[76:77], v164 offset:20736
    v_mul_f32 v30, v30, v30
    v_mul_f32 v31, v31, v31
    v_mul_f32 v32, v32, v32
    v_mul_f32 v33, v33, v33
    s_waitcnt lgkmcnt(7)
    v_mfma_f32_32x32x16_bf16 v[42:57], v[82:85], v[122:125], v[42:57]
    ds_read_b64_tr_b16 v[78:79], v164 offset:21504
    ds_read_b64_tr_b16 v[80:81], v164 offset:21760
    v_cvt_pk_bf16_f32 v134, v26, v27
    v_cvt_pk_bf16_f32 v135, v28, v29
    v_cvt_pk_bf16_f32 v136, v30, v31
    v_cvt_pk_bf16_f32 v137, v32, v33
    s_waitcnt lgkmcnt(7)
    v_mfma_f32_32x32x16_bf16 v[42:57], v[86:89], v[126:129], v[42:57]
    ds_read_b64_tr_b16 v[82:83], v164 offset:22528
    ds_read_b64_tr_b16 v[84:85], v164 offset:22784
    buffer_store_dwordx4 v[134:137], v165, s[4:7], s82 offen offset:0 sc1
    v_max_f32 v34, 0, v34
    v_max_f32 v35, 0, v35
    v_max_f32 v36, 0, v36
    s_waitcnt lgkmcnt(8)
    v_mfma_f32_32x32x16_bf16 v[42:57], v[90:93], v[130:133], v[42:57]
    ds_read_b64_tr_b16 v[86:87], v164 offset:23552
    ds_read_b64_tr_b16 v[88:89], v164 offset:23808
    v_max_f32 v37, 0, v37
    v_max_f32 v38, 0, v38
    v_max_f32 v39, 0, v39
    v_max_f32 v40, 0, v40
    s_waitcnt lgkmcnt(8)
    v_mfma_f32_32x32x16_bf16 v[58:73], v[94:97], v[158:161], v[58:73]
    ds_read_b64_tr_b16 v[90:91], v164 offset:32768
    ds_read_b64_tr_b16 v[92:93], v164 offset:33024
    v_max_f32 v41, 0, v41
    v_mul_f32 v34, v34, v15
    v_mul_f32 v35, v35, v15
    v_mul_f32 v36, v36, v15
    s_waitcnt lgkmcnt(8)
    v_mfma_f32_32x32x16_bf16 v[58:73], v[74:77], v[98:101], v[58:73]
    ds_read_b64_tr_b16 v[94:95], v164 offset:33792
    ds_read_b64_tr_b16 v[96:97], v164 offset:34048
    v_mul_f32 v37, v37, v15
    v_mul_f32 v38, v38, v15
    v_mul_f32 v39, v39, v15
    v_mul_f32 v40, v40, v15
    s_waitcnt lgkmcnt(8)
    v_mfma_f32_32x32x16_bf16 v[58:73], v[78:81], v[102:105], v[58:73]
    ds_read_b64_tr_b16 v[74:75], v164 offset:34816
    ds_read_b64_tr_b16 v[76:77], v164 offset:35072
    v_mul_f32 v41, v41, v15
    v_mul_f32 v34, v34, v34
    v_mul_f32 v35, v35, v35
    v_mul_f32 v36, v36, v36
    s_waitcnt lgkmcnt(8)
    v_mfma_f32_32x32x16_bf16 v[58:73], v[82:85], v[106:109], v[58:73]
    ds_read_b64_tr_b16 v[78:79], v164 offset:35840
    ds_read_b64_tr_b16 v[80:81], v164 offset:36096
    v_mul_f32 v37, v37, v37
    v_mul_f32 v38, v38, v38
    v_mul_f32 v39, v39, v39
    v_mul_f32 v40, v40, v40
    s_waitcnt lgkmcnt(8)
    v_mfma_f32_32x32x16_bf16 v[58:73], v[86:89], v[110:113], v[58:73]
    ds_read_b64 v[82:83], v14 offset:512
    v_mul_f32 v41, v41, v41
    v_cvt_pk_bf16_f32 v138, v34, v35
    v_cvt_pk_bf16_f32 v139, v36, v37
    v_cvt_pk_bf16_f32 v140, v38, v39
    s_waitcnt lgkmcnt(7)
    v_mfma_f32_32x32x16_bf16 v[58:73], v[90:93], v[114:117], v[58:73]
    v_cvt_pk_bf16_f32 v141, v40, v41
    buffer_store_dwordx4 v[138:141], v165, s[4:7], s82 offen offset:512 sc1
    v_max_f32 v42, 0, v42
    v_max_f32 v43, 0, v43
    s_waitcnt lgkmcnt(5)
    v_mfma_f32_32x32x16_bf16 v[58:73], v[94:97], v[118:121], v[58:73]
    v_max_f32 v44, 0, v44
    v_max_f32 v45, 0, v45
    v_max_f32 v46, 0, v46
    v_max_f32 v47, 0, v47
    s_waitcnt lgkmcnt(3)
    v_mfma_f32_32x32x16_bf16 v[58:73], v[74:77], v[122:125], v[58:73]
    v_max_f32 v48, 0, v48
    v_max_f32 v49, 0, v49
    v_mul_f32 v42, v42, v15
    v_mul_f32 v43, v43, v15
    s_waitcnt lgkmcnt(1)
    v_mfma_f32_32x32x16_bf16 v[58:73], v[78:81], v[126:129], v[58:73]
    v_mul_f32 v44, v44, v15
    v_mul_f32 v45, v45, v15
    v_mul_f32 v46, v46, v15
    v_mul_f32 v47, v47, v15
    s_waitcnt lgkmcnt(0)
    v_mfma_f32_32x32x16_bf16 v[58:73], v[82:85], v[130:133], v[58:73]
    v_mul_f32 v48, v48, v15
    v_mul_f32 v49, v49, v15
    v_mul_f32 v42, v42, v42
    v_mul_f32 v43, v43, v43
    v_mul_f32 v44, v44, v44
    v_mul_f32 v45, v45, v45
    v_mul_f32 v46, v46, v46
    v_mul_f32 v47, v47, v47
    v_mul_f32 v48, v48, v48
    v_mul_f32 v49, v49, v49
    v_cvt_pk_bf16_f32 v142, v42, v43
    v_cvt_pk_bf16_f32 v143, v44, v45
    v_cvt_pk_bf16_f32 v144, v46, v47
    v_cvt_pk_bf16_f32 v145, v48, v49
    buffer_store_dwordx4 v[142:145], v165, s[4:7], s82 offen offset:1024 sc1
    v_max_f32 v50, 0, v50
    v_max_f32 v51, 0, v51
    v_max_f32 v52, 0, v52
    v_max_f32 v53, 0, v53
    v_max_f32 v54, 0, v54
    v_max_f32 v55, 0, v55
    v_max_f32 v56, 0, v56
    v_max_f32 v57, 0, v57
    v_mul_f32 v50, v50, v15
    v_mul_f32 v51, v51, v15
    v_mul_f32 v52, v52, v15
    v_mul_f32 v53, v53, v15
    v_mul_f32 v54, v54, v15
    v_mul_f32 v55, v55, v15
    v_mul_f32 v56, v56, v15
    v_mul_f32 v57, v57, v15
    v_mul_f32 v50, v50, v50
    v_mul_f32 v51, v51, v51
    v_mul_f32 v52, v52, v52
    v_mul_f32 v53, v53, v53
    v_mul_f32 v54, v54, v54
    v_mul_f32 v55, v55, v55
    v_mul_f32 v56, v56, v56
    v_mul_f32 v57, v57, v57
    v_cvt_pk_bf16_f32 v146, v50, v51
    v_cvt_pk_bf16_f32 v147, v52, v53
    v_cvt_pk_bf16_f32 v148, v54, v55
    v_cvt_pk_bf16_f32 v149, v56, v57
    buffer_store_dwordx4 v[146:149], v165, s[4:7], s82 offen offset:1536 sc1
    v_max_f32 v58, 0, v58
    v_max_f32 v59, 0, v59
    v_max_f32 v60, 0, v60
    v_max_f32 v61, 0, v61
    v_max_f32 v62, 0, v62
    v_max_f32 v63, 0, v63
    v_max_f32 v64, 0, v64
    v_max_f32 v65, 0, v65
    v_pk_mul_f32 v[58:59], v[58:59], v[14:15] op_sel:[0,1] op_sel_hi:[1,1]
    v_pk_mul_f32 v[60:61], v[60:61], v[14:15] op_sel:[0,1] op_sel_hi:[1,1]
    v_pk_mul_f32 v[62:63], v[62:63], v[14:15] op_sel:[0,1] op_sel_hi:[1,1]
    v_pk_mul_f32 v[64:65], v[64:65], v[14:15] op_sel:[0,1] op_sel_hi:[1,1]
    v_pk_mul_f32 v[58:59], v[58:59], v[58:59]
    v_pk_mul_f32 v[60:61], v[60:61], v[60:61]
    v_pk_mul_f32 v[62:63], v[62:63], v[62:63]
    v_pk_mul_f32 v[64:65], v[64:65], v[64:65]
    v_cvt_pk_bf16_f32 v150, v58, v59
    v_cvt_pk_bf16_f32 v151, v60, v61
    v_cvt_pk_bf16_f32 v152, v62, v63
    v_cvt_pk_bf16_f32 v153, v64, v65
    buffer_store_dwordx4 v[150:153], v165, s[4:7], s83 offen offset:0 sc1
    v_max_f32 v66, 0, v66
    v_max_f32 v67, 0, v67
    v_max_f32 v68, 0, v68
    v_max_f32 v69, 0, v69
    v_max_f32 v70, 0, v70
    v_max_f32 v71, 0, v71
    v_max_f32 v72, 0, v72
    v_max_f32 v73, 0, v73
    v_pk_mul_f32 v[66:67], v[66:67], v[14:15] op_sel:[0,1] op_sel_hi:[1,1]
    v_pk_mul_f32 v[68:69], v[68:69], v[14:15] op_sel:[0,1] op_sel_hi:[1,1]
    v_pk_mul_f32 v[70:71], v[70:71], v[14:15] op_sel:[0,1] op_sel_hi:[1,1]
    v_pk_mul_f32 v[72:73], v[72:73], v[14:15] op_sel:[0,1] op_sel_hi:[1,1]
    v_pk_mul_f32 v[66:67], v[66:67], v[66:67]
    v_pk_mul_f32 v[68:69], v[68:69], v[68:69]
    v_pk_mul_f32 v[70:71], v[70:71], v[70:71]
    v_pk_mul_f32 v[72:73], v[72:73], v[72:73]
    v_cvt_pk_bf16_f32 v154, v66, v67
    v_cvt_pk_bf16_f32 v155, v68, v69
    v_cvt_pk_bf16_f32 v156, v70, v71
    v_cvt_pk_bf16_f32 v157, v72, v73
    buffer_store_dwordx4 v[154:157], v165, s[4:7], s83 offen offset:512 sc1
    s_barrier
    v_lshrrev_b32 v15, 4, v0
    v_lshlrev_b32 v15, 3, v15
    v_add_u32 v16, 161600, v15
    ds_read_b64 v[142:143], v16 offset:0
    ds_read_b64 v[144:145], v16 offset:32
    ds_read_b64 v[146:147], v16 offset:64
    ds_read_b64 v[148:149], v16 offset:96
    ds_read_b64 v[150:151], v16 offset:128
    s_lshl1_add_u32 s52, s43, 0
    s_and_b32 s52, s52, 7
    s_mul_i32 s52, s52, 3072
    s_add_u32 s58, s86, s52
    s_lshl1_add_u32 s52, s43, 1
    s_and_b32 s52, s52, 7
    s_mul_i32 s52, s52, 3072
    s_add_u32 s59, s86, s52
    s_lshl1_add_u32 s52, s43, 2
    s_and_b32 s52, s52, 7
    s_mul_i32 s52, s52, 3072
    s_add_u32 s60, s86, s52
    s_lshl1_add_u32 s52, s43, 3
    s_and_b32 s52, s52, 7
    s_mul_i32 s52, s52, 3072
    s_add_u32 s61, s86, s52
    s_lshl1_add_u32 s52, s43, 4
    s_and_b32 s52, s52, 7
    s_mul_i32 s52, s52, 3072
    s_add_u32 s62, s86, s52
    s_lshl1_add_u32 s52, s43, 5
    s_and_b32 s52, s52, 7
    s_mul_i32 s52, s52, 3072
    s_add_u32 s63, s86, s52
    s_lshl1_add_u32 s52, s43, 6
    s_and_b32 s52, s52, 7
    s_mul_i32 s52, s52, 3072
    s_add_u32 s64, s86, s52
    s_lshl1_add_u32 s52, s43, 7
    s_and_b32 s52, s52, 7
    s_mul_i32 s52, s52, 3072
    s_add_u32 s65, s86, s52
    v_permlane16_swap_b32 v2, v4
    v_permlane16_swap_b32 v3, v5
    v_permlane16_swap_b32 v6, v8
    v_permlane16_swap_b32 v7, v9
    v_and_b32 v17, 28, v22
    v_mov_b32 v14, s45
    s_mov_b64 exec, 1
    s_waitcnt vmcnt(0)
    s_cmp_eq_u32 s46, 0
    s_cbranch_scc1 .slow_73
    buffer_store_dword v14, off, s[4:7], s84
.join_74:
    s_mov_b64 exec, -1
    buffer_load_dword v94, v17, s[4:7], s85 offen sc1
    v_add_u32 v20, 0x17100, v20
    v_add_u32 v21, 0x17100, v21
    ds_read_b64_tr_b16 v[66:67], v20 offset:0
    ds_read_b64_tr_b16 v[68:69], v20 offset:256
    ds_read_b64_tr_b16 v[70:71], v20 offset:32
    ds_read_b64_tr_b16 v[72:73], v20 offset:288
    ds_read_b64_tr_b16 v[74:75], v20 offset:64
    ds_read_b64_tr_b16 v[76:77], v20 offset:320
    ds_read_b64_tr_b16 v[78:79], v20 offset:96
    ds_read_b64_tr_b16 v[80:81], v20 offset:352
    ds_read_b128 v[82:85], v21 offset:8448
    s_and_b32 s53, s38, 1
    s_mul_i32 s52, s53, 49152
    v_add_u32 v24, s52, v1
    s_sub_u32 s52, 49152, s52
    v_add_u32 v25, s52, v1
    s_waitcnt lgkmcnt(9)
    v_lshlrev_b32 v26, 16, v2
    v_and_b32 v27, 0xffff0000, v2
    v_lshlrev_b32 v46, 16, v142
    v_and_b32 v47, 0xffff0000, v142
    v_lshlrev_b32 v28, 16, v3
    v_and_b32 v29, 0xffff0000, v3
    v_lshlrev_b32 v48, 16, v143
    v_and_b32 v49, 0xffff0000, v143
    v_lshlrev_b32 v30, 16, v4
    v_and_b32 v31, 0xffff0000, v4
    v_lshlrev_b32 v50, 16, v144
    v_and_b32 v51, 0xffff0000, v144
    v_lshlrev_b32 v32, 16, v5
    v_and_b32 v33, 0xffff0000, v5
    v_lshlrev_b32 v52, 16, v145
    v_and_b32 v53, 0xffff0000, v145
    v_lshlrev_b32 v34, 16, v6
    v_and_b32 v35, 0xffff0000, v6
    v_lshlrev_b32 v54, 16, v146
    v_and_b32 v55, 0xffff0000, v146
    v_lshlrev_b32 v36, 16, v7
    v_and_b32 v37, 0xffff0000, v7
    v_lshlrev_b32 v56, 16, v147
    v_and_b32 v57, 0xffff0000, v147
    v_lshlrev_b32 v38, 16, v8
    v_and_b32 v39, 0xffff0000, v8
    v_lshlrev_b32 v58, 16, v148
    v_and_b32 v59, 0xffff0000, v148
    v_lshlrev_b32 v40, 16, v9
    v_and_b32 v41, 0xffff0000, v9
    v_lshlrev_b32 v60, 16, v149
    v_and_b32 v61, 0xffff0000, v149
    v_lshlrev_b32 v42, 16, v10
    v_and_b32 v43, 0xffff0000, v10
    v_lshlrev_b32 v62, 16, v150
    v_and_b32 v63, 0xffff0000, v150
    v_lshlrev_b32 v44, 16, v11
    v_and_b32 v45, 0xffff0000, v11
    v_lshlrev_b32 v64, 16, v151
    v_and_b32 v65, 0xffff0000, v151
    v_pk_add_f32 v[26:27], v[26:27], v[46:47]
    v_pk_add_f32 v[28:29], v[28:29], v[48:49]
    v_pk_add_f32 v[30:31], v[30:31], v[50:51]
    v_pk_add_f32 v[32:33], v[32:33], v[52:53]
    v_pk_add_f32 v[34:35], v[34:35], v[54:55]
    v_pk_add_f32 v[36:37], v[36:37], v[56:57]
    v_pk_add_f32 v[38:39], v[38:39], v[58:59]
    v_pk_add_f32 v[40:41], v[40:41], v[60:61]
    v_pk_add_f32 v[42:43], v[42:43], v[62:63]
    v_pk_add_f32 v[44:45], v[44:45], v[64:65]
    s_mov_b32 s47, 65536
.poll_75:
    buffer_load_dword v95, v17, s[4:7], s85 offen sc1
    s_waitcnt vmcnt(1)
    v_cmp_ne_u32 vcc, s45, v94
    s_cmp_eq_u64 vcc, 0
    s_cbranch_scc1 .polld_76
    buffer_load_dword v94, v17, s[4:7], s85 offen sc1
    s_waitcnt vmcnt(1)
    v_cmp_ne_u32 vcc, s45, v95
    s_cmp_eq_u64 vcc, 0
    s_cbranch_scc1 .polld_76
    s_sub_u32 s47, s47, 1
    s_cbranch_scc0 .poll_75
.polld_76:
    buffer_load_dwordx4 v[90:93], v24, s[4:7], s58 offen offset:0 sc1
    buffer_load_dwordx4 v[94:97], v25, s[4:7], s58 offen offset:0 sc1
    buffer_load_dwordx4 v[98:101], v24, s[4:7], s58 offen offset:1024 sc1
    buffer_load_dwordx4 v[102:105], v25, s[4:7], s58 offen offset:1024 sc1
    buffer_load_dwordx4 v[106:109], v24, s[4:7], s58 offen offset:2048 sc1
    buffer_load_dwordx4 v[110:113], v25, s[4:7], s58 offen offset:2048 sc1
    buffer_load_dwordx4 v[114:117], v24, s[4:7], s59 offen offset:0 sc1
    buffer_load_dwordx4 v[118:121], v25, s[4:7], s59 offen offset:0 sc1
    buffer_load_dwordx4 v[122:125], v24, s[4:7], s59 offen offset:1024 sc1
    buffer_load_dwordx4 v[126:129], v25, s[4:7], s59 offen offset:1024 sc1
    buffer_load_dwordx4 v[130:133], v24, s[4:7], s59 offen offset:2048 sc1
    buffer_load_dwordx4 v[134:137], v25, s[4:7], s59 offen offset:2048 sc1
    buffer_load_dwordx4 v[138:141], v24, s[4:7], s60 offen offset:0 sc1
    buffer_load_dwordx4 v[142:145], v25, s[4:7], s60 offen offset:0 sc1
    buffer_load_dwordx4 v[146:149], v24, s[4:7], s60 offen offset:1024 sc1
    buffer_load_dwordx4 v[150:153], v25, s[4:7], s60 offen offset:1024 sc1
    v_mul_u32_u24 v16, 640, v22
    v_add_u32 v19, v16, v15
    v_lshrrev_b32 v18, 8, v18
    v_lshl_add_u32 v18, v18, 4, v16
    v_add_u32 v23, 0xffffae00, v23
    s_waitcnt vmcnt(15) lgkmcnt(7)
    v_mfma_f32_16x16x32_bf16 v[26:29], v[66:69], v[90:93], v[26:29]
    ds_read_b64_tr_b16 v[86:87], v20 offset:10496
    s_waitcnt vmcnt(14)
    v_mfma_f32_16x16x32_bf16 v[46:49], v[66:69], v[94:97], 0
    ds_read_b64_tr_b16 v[88:89], v20 offset:10752
    s_waitcnt lgkmcnt(7)
    v_mfma_f32_16x16x32_bf16 v[30:33], v[70:73], v[90:93], v[30:33]
    ds_read_b64_tr_b16 v[66:67], v20 offset:10528
    v_mfma_f32_16x16x32_bf16 v[50:53], v[70:73], v[94:97], 0
    ds_read_b64_tr_b16 v[68:69], v20 offset:10784
    s_waitcnt lgkmcnt(7)
    v_mfma_f32_16x16x32_bf16 v[34:37], v[74:77], v[90:93], v[34:37]
    ds_read_b64_tr_b16 v[70:71], v20 offset:10560
    v_mfma_f32_16x16x32_bf16 v[54:57], v[74:77], v[94:97], 0
    ds_read_b64_tr_b16 v[72:73], v20 offset:10816
    s_waitcnt lgkmcnt(7)
    v_mfma_f32_16x16x32_bf16 v[38:41], v[78:81], v[90:93], v[38:41]
    ds_read_b64_tr_b16 v[74:75], v20 offset:10592
    v_mfma_f32_16x16x32_bf16 v[58:61], v[78:81], v[94:97], 0
    ds_read_b64_tr_b16 v[76:77], v20 offset:10848
    s_waitcnt lgkmcnt(8)
    v_mfma_f32_16x16x32_bf16 v[42:45], v[82:85], v[90:93], v[42:45]
    ds_read_b128 v[78:81], v21 offset:18944
    buffer_load_dwordx4 v[90:93], v24, s[4:7], s60 offen offset:2048 sc1
    v_mfma_f32_16x16x32_bf16 v[62:65], v[82:85], v[94:97], 0
    buffer_load_dwordx4 v[94:97], v25, s[4:7], s60 offen offset:2048 sc1
    s_waitcnt vmcnt(14) lgkmcnt(7)
    v_mfma_f32_16x16x32_bf16 v[26:29], v[86:89], v[98:101], v[26:29]
    v_add_u32 v20, 0xfffe8f00, v20
    v_add_u32 v21, 0xfffe8f00, v21
    ds_read_b64_tr_b16 v[82:83], v20 offset:0
    v_mfma_f32_16x16x32_bf16 v[46:49], v[86:89], v[102:105], v[46:49]
    ds_read_b64_tr_b16 v[84:85], v20 offset:256
    s_waitcnt lgkmcnt(7)
    v_mfma_f32_16x16x32_bf16 v[30:33], v[66:69], v[98:101], v[30:33]
    ds_read_b64_tr_b16 v[86:87], v20 offset:32
    v_mfma_f32_16x16x32_bf16 v[50:53], v[66:69], v[102:105], v[50:53]
    ds_read_b64_tr_b16 v[88:89], v20 offset:288
    s_waitcnt lgkmcnt(7)
    v_mfma_f32_16x16x32_bf16 v[34:37], v[70:73], v[98:101], v[34:37]
    ds_read_b64_tr_b16 v[66:67], v20 offset:64
    v_mfma_f32_16x16x32_bf16 v[54:57], v[70:73], v[102:105], v[54:57]
    ds_read_b64_tr_b16 v[68:69], v20 offset:320
    s_waitcnt lgkmcnt(7)
    v_mfma_f32_16x16x32_bf16 v[38:41], v[74:77], v[98:101], v[38:41]
    ds_read_b64_tr_b16 v[70:71], v20 offset:96
    v_mfma_f32_16x16x32_bf16 v[58:61], v[74:77], v[102:105], v[58:61]
    ds_read_b64_tr_b16 v[72:73], v20 offset:352
    s_waitcnt lgkmcnt(8)
    v_mfma_f32_16x16x32_bf16 v[42:45], v[78:81], v[98:101], v[42:45]
    ds_read_b128 v[74:77], v21 offset:8448
    buffer_load_dwordx4 v[98:101], v24, s[4:7], s61 offen offset:0 sc1
    v_mfma_f32_16x16x32_bf16 v[62:65], v[78:81], v[102:105], v[62:65]
    buffer_load_dwordx4 v[102:105], v25, s[4:7], s61 offen offset:0 sc1
    s_barrier
    s_waitcnt vmcnt(14) lgkmcnt(7)
    v_mfma_f32_16x16x32_bf16 v[26:29], v[82:85], v[106:109], v[26:29]
    ds_read_b64_tr_b16 v[78:79], v20 offset:10496
    v_mfma_f32_16x16x32_bf16 v[46:49], v[82:85], v[110:113], v[46:49]
    ds_read_b64_tr_b16 v[80:81], v20 offset:10752
    s_waitcnt lgkmcnt(7)
    v_mfma_f32_16x16x32_bf16 v[30:33], v[86:89], v[106:109], v[30:33]
    ds_read_b64_tr_b16 v[82:83], v20 offset:10528
    v_mfma_f32_16x16x32_bf16 v[50:53], v[86:89], v[110:113], v[50:53]
    ds_read_b64_tr_b16 v[84:85], v20 offset:10784
    s_waitcnt lgkmcnt(7)
    v_mfma_f32_16x16x32_bf16 v[34:37], v[66:69], v[106:109], v[34:37]
    ds_read_b64_tr_b16 v[86:87], v20 offset:10560
    v_mfma_f32_16x16x32_bf16 v[54:57], v[66:69], v[110:113], v[54:57]
    ds_read_b64_tr_b16 v[88:89], v20 offset:10816
    s_waitcnt lgkmcnt(7)
    v_mfma_f32_16x16x32_bf16 v[38:41], v[70:73], v[106:109], v[38:41]
    ds_read_b64_tr_b16 v[66:67], v20 offset:10592
    v_mfma_f32_16x16x32_bf16 v[58:61], v[70:73], v[110:113], v[58:61]
    ds_read_b64_tr_b16 v[68:69], v20 offset:10848
    s_waitcnt lgkmcnt(8)
    v_mfma_f32_16x16x32_bf16 v[42:45], v[74:77], v[106:109], v[42:45]
    ds_read_b128 v[70:73], v21 offset:18944
    buffer_load_dwordx4 v[106:109], v24, s[4:7], s61 offen offset:1024 sc1
    v_mfma_f32_16x16x32_bf16 v[62:65], v[74:77], v[110:113], v[62:65]
    buffer_load_dwordx4 v[110:113], v25, s[4:7], s61 offen offset:1024 sc1
    s_waitcnt vmcnt(14) lgkmcnt(7)
    v_mfma_f32_16x16x32_bf16 v[26:29], v[78:81], v[114:117], v[26:29]
    ds_read_b64_tr_b16 v[74:75], v20 offset:20992
    v_mfma_f32_16x16x32_bf16 v[46:49], v[78:81], v[118:121], v[46:49]
    ds_read_b64_tr_b16 v[76:77], v20 offset:21248
    s_waitcnt lgkmcnt(7)
    v_mfma_f32_16x16x32_bf16 v[30:33], v[82:85], v[114:117], v[30:33]
    ds_read_b64_tr_b16 v[78:79], v20 offset:21024
    v_mfma_f32_16x16x32_bf16 v[50:53], v[82:85], v[118:121], v[50:53]
    ds_read_b64_tr_b16 v[80:81], v20 offset:21280
    s_waitcnt lgkmcnt(7)
    v_mfma_f32_16x16x32_bf16 v[34:37], v[86:89], v[114:117], v[34:37]
    ds_read_b64_tr_b16 v[82:83], v20 offset:21056
    v_mfma_f32_16x16x32_bf16 v[54:57], v[86:89], v[118:121], v[54:57]
    ds_read_b64_tr_b16 v[84:85], v20 offset:21312
    s_waitcnt lgkmcnt(7)
    v_mfma_f32_16x16x32_bf16 v[38:41], v[66:69], v[114:117], v[38:41]
    ds_read_b64_tr_b16 v[86:87], v20 offset:21088
    v_mfma_f32_16x16x32_bf16 v[58:61], v[66:69], v[118:121], v[58:61]
    ds_read_b64_tr_b16 v[88:89], v20 offset:21344
    s_waitcnt lgkmcnt(8)
    v_mfma_f32_16x16x32_bf16 v[42:45], v[70:73], v[114:117], v[42:45]
    ds_read_b128 v[66:69], v21 offset:29440
    buffer_load_dwordx4 v[114:117], v24, s[4:7], s61 offen offset:2048 sc1
    v_mfma_f32_16x16x32_bf16 v[62:65], v[70:73], v[118:121], v[62:65]
    buffer_load_dwordx4 v[118:121], v25, s[4:7], s61 offen offset:2048 sc1
    s_waitcnt vmcnt(14) lgkmcnt(7)
    v_mfma_f32_16x16x32_bf16 v[26:29], v[74:77], v[122:125], v[26:29]
    ds_read_b64_tr_b16 v[70:71], v20 offset:31488
    v_mfma_f32_16x16x32_bf16 v[46:49], v[74:77], v[126:129], v[46:49]
    ds_read_b64_tr_b16 v[72:73], v20 offset:31744
    s_waitcnt lgkmcnt(7)
    v_mfma_f32_16x16x32_bf16 v[30:33], v[78:81], v[122:125], v[30:33]
    ds_read_b64_tr_b16 v[74:75], v20 offset:31520
    v_mfma_f32_16x16x32_bf16 v[50:53], v[78:81], v[126:129], v[50:53]
    ds_read_b64_tr_b16 v[76:77], v20 offset:31776
    s_waitcnt lgkmcnt(7)
    v_mfma_f32_16x16x32_bf16 v[34:37], v[82:85], v[122:125], v[34:37]
    ds_read_b64_tr_b16 v[78:79], v20 offset:31552
    v_mfma_f32_16x16x32_bf16 v[54:57], v[82:85], v[126:129], v[54:57]
    ds_read_b64_tr_b16 v[80:81], v20 offset:31808
    s_waitcnt lgkmcnt(7)
    v_mfma_f32_16x16x32_bf16 v[38:41], v[86:89], v[122:125], v[38:41]
    ds_read_b64_tr_b16 v[82:83], v20 offset:31584
    v_mfma_f32_16x16x32_bf16 v[58:61], v[86:89], v[126:129], v[58:61]
    ds_read_b64_tr_b16 v[84:85], v20 offset:31840
    s_waitcnt lgkmcnt(8)
    v_mfma_f32_16x16x32_bf16 v[42:45], v[66:69], v[122:125], v[42:45]
    ds_read_b128 v[86:89], v21 offset:39936
    buffer_load_dwordx4 v[122:125], v24, s[4:7], s62 offen offset:0 sc1
    v_mfma_f32_16x16x32_bf16 v[62:65], v[66:69], v[126:129], v[62:65]
    buffer_load_dwordx4 v[126:129], v25, s[4:7], s62 offen offset:0 sc1
    s_waitcnt vmcnt(14) lgkmcnt(7)
    v_mfma_f32_16x16x32_bf16 v[26:29], v[70:73], v[130:133], v[26:29]
    ds_read_b64_tr_b16 v[66:67], v20 offset:41984
    v_mfma_f32_16x16x32_bf16 v[46:49], v[70:73], v[134:137], v[46:49]
    ds_read_b64_tr_b16 v[68:69], v20 offset:42240
    s_waitcnt lgkmcnt(7)
    v_mfma_f32_16x16x32_bf16 v[30:33], v[74:77], v[130:133], v[30:33]
    ds_read_b64_tr_b16 v[70:71], v20 offset:42016
    v_mfma_f32_16x16x32_bf16 v[50:53], v[74:77], v[134:137], v[50:53]
    ds_read_b64_tr_b16 v[72:73], v20 offset:42272
    s_waitcnt lgkmcnt(7)
    v_mfma_f32_16x16x32_bf16 v[34:37], v[78:81], v[130:133], v[34:37]
    ds_read_b64_tr_b16 v[74:75], v20 offset:42048
    v_mfma_f32_16x16x32_bf16 v[54:57], v[78:81], v[134:137], v[54:57]
    ds_read_b64_tr_b16 v[76:77], v20 offset:42304
    s_waitcnt lgkmcnt(7)
    v_mfma_f32_16x16x32_bf16 v[38:41], v[82:85], v[130:133], v[38:41]
    ds_read_b64_tr_b16 v[78:79], v20 offset:42080
    v_mfma_f32_16x16x32_bf16 v[58:61], v[82:85], v[134:137], v[58:61]
    ds_read_b64_tr_b16 v[80:81], v20 offset:42336
    s_waitcnt lgkmcnt(8)
    v_mfma_f32_16x16x32_bf16 v[42:45], v[86:89], v[130:133], v[42:45]
    ds_read_b128 v[82:85], v21 offset:50432
    buffer_load_dwordx4 v[130:133], v24, s[4:7], s62 offen offset:1024 sc1
    v_mfma_f32_16x16x32_bf16 v[62:65], v[86:89], v[134:137], v[62:65]
    buffer_load_dwordx4 v[134:137], v25, s[4:7], s62 offen offset:1024 sc1
    s_barrier
    s_waitcnt vmcnt(14) lgkmcnt(7)
    v_mfma_f32_16x16x32_bf16 v[26:29], v[66:69], v[138:141], v[26:29]
    ds_read_b64_tr_b16 v[86:87], v20 offset:52480
    v_mfma_f32_16x16x32_bf16 v[46:49], v[66:69], v[142:145], v[46:49]
    ds_read_b64_tr_b16 v[88:89], v20 offset:52736
    s_waitcnt lgkmcnt(7)
    v_mfma_f32_16x16x32_bf16 v[30:33], v[70:73], v[138:141], v[30:33]
    ds_read_b64_tr_b16 v[66:67], v20 offset:52512
    v_mfma_f32_16x16x32_bf16 v[50:53], v[70:73], v[142:145], v[50:53]
    ds_read_b64_tr_b16 v[68:69], v20 offset:52768
    s_waitcnt lgkmcnt(7)
    v_mfma_f32_16x16x32_bf16 v[34:37], v[74:77], v[138:141], v[34:37]
    ds_read_b64_tr_b16 v[70:71], v20 offset:52544
    v_mfma_f32_16x16x32_bf16 v[54:57], v[74:77], v[142:145], v[54:57]
    ds_read_b64_tr_b16 v[72:73], v20 offset:52800
    s_waitcnt lgkmcnt(7)
    v_mfma_f32_16x16x32_bf16 v[38:41], v[78:81], v[138:141], v[38:41]
    ds_read_b64_tr_b16 v[74:75], v20 offset:52576
    v_mfma_f32_16x16x32_bf16 v[58:61], v[78:81], v[142:145], v[58:61]
    ds_read_b64_tr_b16 v[76:77], v20 offset:52832
    s_waitcnt lgkmcnt(8)
    v_mfma_f32_16x16x32_bf16 v[42:45], v[82:85], v[138:141], v[42:45]
    ds_read_b128 v[78:81], v21 offset:60928
    buffer_load_dwordx4 v[138:141], v24, s[4:7], s62 offen offset:2048 sc1
    v_mfma_f32_16x16x32_bf16 v[62:65], v[82:85], v[142:145], v[62:65]
    buffer_load_dwordx4 v[142:145], v25, s[4:7], s62 offen offset:2048 sc1
    s_waitcnt vmcnt(14) lgkmcnt(7)
    v_mfma_f32_16x16x32_bf16 v[26:29], v[86:89], v[146:149], v[26:29]
    v_add_u32 v20, 0xf600, v20
    v_add_u32 v21, 0xf600, v21
    ds_read_b64_tr_b16 v[82:83], v20 offset:0
    v_mfma_f32_16x16x32_bf16 v[46:49], v[86:89], v[150:153], v[46:49]
    ds_read_b64_tr_b16 v[84:85], v20 offset:256
    s_waitcnt lgkmcnt(7)
    v_mfma_f32_16x16x32_bf16 v[30:33], v[66:69], v[146:149], v[30:33]
    ds_read_b64_tr_b16 v[86:87], v20 offset:32
    v_mfma_f32_16x16x32_bf16 v[50:53], v[66:69], v[150:153], v[50:53]
    ds_read_b64_tr_b16 v[88:89], v20 offset:288
    s_waitcnt lgkmcnt(7)
    v_mfma_f32_16x16x32_bf16 v[34:37], v[70:73], v[146:149], v[34:37]
    ds_read_b64_tr_b16 v[66:67], v20 offset:64
    v_mfma_f32_16x16x32_bf16 v[54:57], v[70:73], v[150:153], v[54:57]
    ds_read_b64_tr_b16 v[68:69], v20 offset:320
    s_waitcnt lgkmcnt(7)
    v_mfma_f32_16x16x32_bf16 v[38:41], v[74:77], v[146:149], v[38:41]
    ds_read_b64_tr_b16 v[70:71], v20 offset:96
    v_mfma_f32_16x16x32_bf16 v[58:61], v[74:77], v[150:153], v[58:61]
    ds_read_b64_tr_b16 v[72:73], v20 offset:352
    s_waitcnt lgkmcnt(8)
    v_mfma_f32_16x16x32_bf16 v[42:45], v[78:81], v[146:149], v[42:45]
    ds_read_b128 v[74:77], v21 offset:8448
    buffer_load_dwordx4 v[146:149], v24, s[4:7], s63 offen offset:0 sc1
    v_mfma_f32_16x16x32_bf16 v[62:65], v[78:81], v[150:153], v[62:65]
    buffer_load_dwordx4 v[150:153], v25, s[4:7], s63 offen offset:0 sc1
    s_waitcnt vmcnt(14) lgkmcnt(7)
    v_mfma_f32_16x16x32_bf16 v[26:29], v[82:85], v[90:93], v[26:29]
    ds_read_b64_tr_b16 v[78:79], v20 offset:10496
    v_mfma_f32_16x16x32_bf16 v[46:49], v[82:85], v[94:97], v[46:49]
    ds_read_b64_tr_b16 v[80:81], v20 offset:10752
    s_waitcnt lgkmcnt(7)
    v_mfma_f32_16x16x32_bf16 v[30:33], v[86:89], v[90:93], v[30:33]
    ds_read_b64_tr_b16 v[82:83], v20 offset:10528
    v_mfma_f32_16x16x32_bf16 v[50:53], v[86:89], v[94:97], v[50:53]
    ds_read_b64_tr_b16 v[84:85], v20 offset:10784
    s_waitcnt lgkmcnt(7)
    v_mfma_f32_16x16x32_bf16 v[34:37], v[66:69], v[90:93], v[34:37]
    ds_read_b64_tr_b16 v[86:87], v20 offset:10560
    v_mfma_f32_16x16x32_bf16 v[54:57], v[66:69], v[94:97], v[54:57]
    ds_read_b64_tr_b16 v[88:89], v20 offset:10816
    s_waitcnt lgkmcnt(7)
    v_mfma_f32_16x16x32_bf16 v[38:41], v[70:73], v[90:93], v[38:41]
    ds_read_b64_tr_b16 v[66:67], v20 offset:10592
    v_mfma_f32_16x16x32_bf16 v[58:61], v[70:73], v[94:97], v[58:61]
    ds_read_b64_tr_b16 v[68:69], v20 offset:10848
    s_waitcnt lgkmcnt(8)
    v_mfma_f32_16x16x32_bf16 v[42:45], v[74:77], v[90:93], v[42:45]
    ds_read_b128 v[70:73], v21 offset:18944
    buffer_load_dwordx4 v[90:93], v24, s[4:7], s63 offen offset:1024 sc1
    v_mfma_f32_16x16x32_bf16 v[62:65], v[74:77], v[94:97], v[62:65]
    buffer_load_dwordx4 v[94:97], v25, s[4:7], s63 offen offset:1024 sc1
    s_waitcnt vmcnt(14) lgkmcnt(7)
    v_mfma_f32_16x16x32_bf16 v[26:29], v[78:81], v[98:101], v[26:29]
    ds_read_b64_tr_b16 v[74:75], v20 offset:20992
    v_mfma_f32_16x16x32_bf16 v[46:49], v[78:81], v[102:105], v[46:49]
    ds_read_b64_tr_b16 v[76:77], v20 offset:21248
    s_waitcnt lgkmcnt(7)
    v_mfma_f32_16x16x32_bf16 v[30:33], v[82:85], v[98:101], v[30:33]
    ds_read_b64_tr_b16 v[78:79], v20 offset:21024
    v_mfma_f32_16x16x32_bf16 v[50:53], v[82:85], v[102:105], v[50:53]
    ds_read_b64_tr_b16 v[80:81], v20 offset:21280
    s_waitcnt lgkmcnt(7)
    v_mfma_f32_16x16x32_bf16 v[34:37], v[86:89], v[98:101], v[34:37]
    ds_read_b64_tr_b16 v[82:83], v20 offset:21056
    v_mfma_f32_16x16x32_bf16 v[54:57], v[86:89], v[102:105], v[54:57]
    ds_read_b64_tr_b16 v[84:85], v20 offset:21312
    s_waitcnt lgkmcnt(7)
    v_mfma_f32_16x16x32_bf16 v[38:41], v[66:69], v[98:101], v[38:41]
    ds_read_b64_tr_b16 v[86:87], v20 offset:21088
    v_mfma_f32_16x16x32_bf16 v[58:61], v[66:69], v[102:105], v[58:61]
    ds_read_b64_tr_b16 v[88:89], v20 offset:21344
    s_waitcnt lgkmcnt(8)
    v_mfma_f32_16x16x32_bf16 v[42:45], v[70:73], v[98:101], v[42:45]
    ds_read_b128 v[66:69], v21 offset:29440
    buffer_load_dwordx4 v[98:101], v24, s[4:7], s63 offen offset:2048 sc1
    v_mfma_f32_16x16x32_bf16 v[62:65], v[70:73], v[102:105], v[62:65]
    buffer_load_dwordx4 v[102:105], v25, s[4:7], s63 offen offset:2048 sc1
    s_barrier
    s_waitcnt vmcnt(14) lgkmcnt(7)
    v_mfma_f32_16x16x32_bf16 v[26:29], v[74:77], v[106:109], v[26:29]
    ds_read_b64_tr_b16 v[70:71], v20 offset:52480
    v_mfma_f32_16x16x32_bf16 v[46:49], v[74:77], v[110:113], v[46:49]
    ds_read_b64_tr_b16 v[72:73], v20 offset:52736
    s_waitcnt lgkmcnt(7)
    v_mfma_f32_16x16x32_bf16 v[30:33], v[78:81], v[106:109], v[30:33]
    ds_read_b64_tr_b16 v[74:75], v20 offset:52512
    v_mfma_f32_16x16x32_bf16 v[50:53], v[78:81], v[110:113], v[50:53]
    ds_read_b64_tr_b16 v[76:77], v20 offset:52768
    s_waitcnt lgkmcnt(7)
    v_mfma_f32_16x16x32_bf16 v[34:37], v[82:85], v[106:109], v[34:37]
    ds_read_b64_tr_b16 v[78:79], v20 offset:52544
    v_mfma_f32_16x16x32_bf16 v[54:57], v[82:85], v[110:113], v[54:57]
    ds_read_b64_tr_b16 v[80:81], v20 offset:52800
    s_waitcnt lgkmcnt(7)
    v_mfma_f32_16x16x32_bf16 v[38:41], v[86:89], v[106:109], v[38:41]
    ds_read_b64_tr_b16 v[82:83], v20 offset:52576
    v_mfma_f32_16x16x32_bf16 v[58:61], v[86:89], v[110:113], v[58:61]
    ds_read_b64_tr_b16 v[84:85], v20 offset:52832
    s_waitcnt lgkmcnt(8)
    v_mfma_f32_16x16x32_bf16 v[42:45], v[66:69], v[106:109], v[42:45]
    ds_read_b128 v[86:89], v21 offset:60928
    buffer_load_dwordx4 v[106:109], v24, s[4:7], s64 offen offset:0 sc1
    v_mfma_f32_16x16x32_bf16 v[62:65], v[66:69], v[110:113], v[62:65]
    buffer_load_dwordx4 v[110:113], v25, s[4:7], s64 offen offset:0 sc1
    s_waitcnt vmcnt(14) lgkmcnt(7)
    v_mfma_f32_16x16x32_bf16 v[26:29], v[70:73], v[114:117], v[26:29]
    v_add_u32 v20, 0xf600, v20
    v_add_u32 v21, 0xf600, v21
    ds_read_b64_tr_b16 v[66:67], v20 offset:0
    v_mfma_f32_16x16x32_bf16 v[46:49], v[70:73], v[118:121], v[46:49]
    ds_read_b64_tr_b16 v[68:69], v20 offset:256
    s_waitcnt lgkmcnt(7)
    v_mfma_f32_16x16x32_bf16 v[30:33], v[74:77], v[114:117], v[30:33]
    ds_read_b64_tr_b16 v[70:71], v20 offset:32
    v_mfma_f32_16x16x32_bf16 v[50:53], v[74:77], v[118:121], v[50:53]
    ds_read_b64_tr_b16 v[72:73], v20 offset:288
    s_waitcnt lgkmcnt(7)
    v_mfma_f32_16x16x32_bf16 v[34:37], v[78:81], v[114:117], v[34:37]
    ds_read_b64_tr_b16 v[74:75], v20 offset:64
    v_mfma_f32_16x16x32_bf16 v[54:57], v[78:81], v[118:121], v[54:57]
    ds_read_b64_tr_b16 v[76:77], v20 offset:320
    s_waitcnt lgkmcnt(7)
    v_mfma_f32_16x16x32_bf16 v[38:41], v[82:85], v[114:117], v[38:41]
    ds_read_b64_tr_b16 v[78:79], v20 offset:96
    v_mfma_f32_16x16x32_bf16 v[58:61], v[82:85], v[118:121], v[58:61]
    ds_read_b64_tr_b16 v[80:81], v20 offset:352
    s_waitcnt lgkmcnt(8)
    v_mfma_f32_16x16x32_bf16 v[42:45], v[86:89], v[114:117], v[42:45]
    ds_read_b128 v[82:85], v21 offset:8448
    buffer_load_dwordx4 v[114:117], v24, s[4:7], s64 offen offset:1024 sc1
    v_mfma_f32_16x16x32_bf16 v[62:65], v[86:89], v[118:121], v[62:65]
    buffer_load_dwordx4 v[118:121], v25, s[4:7], s64 offen offset:1024 sc1
    s_waitcnt vmcnt(14) lgkmcnt(7)
    v_mfma_f32_16x16x32_bf16 v[26:29], v[66:69], v[122:125], v[26:29]
    ds_read_b64_tr_b16 v[86:87], v20 offset:10496
    v_mfma_f32_16x16x32_bf16 v[46:49], v[66:69], v[126:129], v[46:49]
    ds_read_b64_tr_b16 v[88:89], v20 offset:10752
    s_waitcnt lgkmcnt(7)
    v_mfma_f32_16x16x32_bf16 v[30:33], v[70:73], v[122:125], v[30:33]
    ds_read_b64_tr_b16 v[66:67], v20 offset:10528
    v_mfma_f32_16x16x32_bf16 v[50:53], v[70:73], v[126:129], v[50:53]
    ds_read_b64_tr_b16 v[68:69], v20 offset:10784
    s_waitcnt lgkmcnt(7)
    v_mfma_f32_16x16x32_bf16 v[34:37], v[74:77], v[122:125], v[34:37]
    ds_read_b64_tr_b16 v[70:71], v20 offset:10560
    v_mfma_f32_16x16x32_bf16 v[54:57], v[74:77], v[126:129], v[54:57]
    ds_read_b64_tr_b16 v[72:73], v20 offset:10816
    s_waitcnt lgkmcnt(7)
    v_mfma_f32_16x16x32_bf16 v[38:41], v[78:81], v[122:125], v[38:41]
    ds_read_b64_tr_b16 v[74:75], v20 offset:10592
    v_mfma_f32_16x16x32_bf16 v[58:61], v[78:81], v[126:129], v[58:61]
    ds_read_b64_tr_b16 v[76:77], v20 offset:10848
    s_waitcnt lgkmcnt(8)
    v_mfma_f32_16x16x32_bf16 v[42:45], v[82:85], v[122:125], v[42:45]
    ds_read_b128 v[78:81], v21 offset:18944
    buffer_load_dwordx4 v[122:125], v24, s[4:7], s64 offen offset:2048 sc1
    v_mfma_f32_16x16x32_bf16 v[62:65], v[82:85], v[126:129], v[62:65]
    buffer_load_dwordx4 v[126:129], v25, s[4:7], s64 offen offset:2048 sc1
    s_waitcnt vmcnt(14) lgkmcnt(7)
    v_mfma_f32_16x16x32_bf16 v[26:29], v[86:89], v[130:133], v[26:29]
    ds_read_b64_tr_b16 v[82:83], v20 offset:20992
    v_mfma_f32_16x16x32_bf16 v[46:49], v[86:89], v[134:137], v[46:49]
    ds_read_b64_tr_b16 v[84:85], v20 offset:21248
    s_waitcnt lgkmcnt(7)
    v_mfma_f32_16x16x32_bf16 v[30:33], v[66:69], v[130:133], v[30:33]
    ds_read_b64_tr_b16 v[86:87], v20 offset:21024
    v_mfma_f32_16x16x32_bf16 v[50:53], v[66:69], v[134:137], v[50:53]
    ds_read_b64_tr_b16 v[88:89], v20 offset:21280
    s_waitcnt lgkmcnt(7)
    v_mfma_f32_16x16x32_bf16 v[34:37], v[70:73], v[130:133], v[34:37]
    ds_read_b64_tr_b16 v[66:67], v20 offset:21056
    v_mfma_f32_16x16x32_bf16 v[54:57], v[70:73], v[134:137], v[54:57]
    ds_read_b64_tr_b16 v[68:69], v20 offset:21312
    s_waitcnt lgkmcnt(7)
    v_mfma_f32_16x16x32_bf16 v[38:41], v[74:77], v[130:133], v[38:41]
    ds_read_b64_tr_b16 v[70:71], v20 offset:21088
    v_mfma_f32_16x16x32_bf16 v[58:61], v[74:77], v[134:137], v[58:61]
    ds_read_b64_tr_b16 v[72:73], v20 offset:21344
    s_waitcnt lgkmcnt(8)
    v_mfma_f32_16x16x32_bf16 v[42:45], v[78:81], v[130:133], v[42:45]
    ds_read_b128 v[74:77], v21 offset:29440
    buffer_load_dwordx4 v[130:133], v24, s[4:7], s65 offen offset:0 sc1
    v_mfma_f32_16x16x32_bf16 v[62:65], v[78:81], v[134:137], v[62:65]
    buffer_load_dwordx4 v[134:137], v25, s[4:7], s65 offen offset:0 sc1
    s_waitcnt vmcnt(14) lgkmcnt(7)
    v_mfma_f32_16x16x32_bf16 v[26:29], v[82:85], v[138:141], v[26:29]
    v_add_u32 v20, 0xffff8500, v20
    v_add_u32 v21, 0xffff8500, v21
    ds_read_b64_tr_b16 v[78:79], v20 offset:0
    v_mfma_f32_16x16x32_bf16 v[46:49], v[82:85], v[142:145], v[46:49]
    ds_read_b64_tr_b16 v[80:81], v20 offset:256
    s_waitcnt lgkmcnt(7)
    v_mfma_f32_16x16x32_bf16 v[30:33], v[86:89], v[138:141], v[30:33]
    ds_read_b64_tr_b16 v[82:83], v20 offset:32
    v_mfma_f32_16x16x32_bf16 v[50:53], v[86:89], v[142:145], v[50:53]
    ds_read_b64_tr_b16 v[84:85], v20 offset:288
    s_waitcnt lgkmcnt(7)
    v_mfma_f32_16x16x32_bf16 v[34:37], v[66:69], v[138:141], v[34:37]
    ds_read_b64_tr_b16 v[86:87], v20 offset:64
    v_mfma_f32_16x16x32_bf16 v[54:57], v[66:69], v[142:145], v[54:57]
    ds_read_b64_tr_b16 v[88:89], v20 offset:320
    s_waitcnt lgkmcnt(7)
    v_mfma_f32_16x16x32_bf16 v[38:41], v[70:73], v[138:141], v[38:41]
    ds_read_b64_tr_b16 v[66:67], v20 offset:96
    v_mfma_f32_16x16x32_bf16 v[58:61], v[70:73], v[142:145], v[58:61]
    ds_read_b64_tr_b16 v[68:69], v20 offset:352
    s_waitcnt lgkmcnt(8)
    v_mfma_f32_16x16x32_bf16 v[42:45], v[74:77], v[138:141], v[42:45]
    ds_read_b128 v[70:73], v21 offset:8448
    buffer_load_dwordx4 v[138:141], v24, s[4:7], s65 offen offset:1024 sc1
    v_mfma_f32_16x16x32_bf16 v[62:65], v[74:77], v[142:145], v[62:65]
    buffer_load_dwordx4 v[142:145], v25, s[4:7], s65 offen offset:1024 sc1
    s_waitcnt vmcnt(14) lgkmcnt(7)
    v_mfma_f32_16x16x32_bf16 v[26:29], v[78:81], v[146:149], v[26:29]
    ds_read_b64_tr_b16 v[74:75], v20 offset:10496
    v_mfma_f32_16x16x32_bf16 v[46:49], v[78:81], v[150:153], v[46:49]
    ds_read_b64_tr_b16 v[76:77], v20 offset:10752
    s_waitcnt lgkmcnt(7)
    v_mfma_f32_16x16x32_bf16 v[30:33], v[82:85], v[146:149], v[30:33]
    ds_read_b64_tr_b16 v[78:79], v20 offset:10528
    v_mfma_f32_16x16x32_bf16 v[50:53], v[82:85], v[150:153], v[50:53]
    ds_read_b64_tr_b16 v[80:81], v20 offset:10784
    s_waitcnt lgkmcnt(7)
    v_mfma_f32_16x16x32_bf16 v[34:37], v[86:89], v[146:149], v[34:37]
    ds_read_b64_tr_b16 v[82:83], v20 offset:10560
    v_mfma_f32_16x16x32_bf16 v[54:57], v[86:89], v[150:153], v[54:57]
    ds_read_b64_tr_b16 v[84:85], v20 offset:10816
    s_waitcnt lgkmcnt(7)
    v_mfma_f32_16x16x32_bf16 v[38:41], v[66:69], v[146:149], v[38:41]
    ds_read_b64_tr_b16 v[86:87], v20 offset:10592
    v_mfma_f32_16x16x32_bf16 v[58:61], v[66:69], v[150:153], v[58:61]
    ds_read_b64_tr_b16 v[88:89], v20 offset:10848
    s_waitcnt lgkmcnt(8)
    v_mfma_f32_16x16x32_bf16 v[42:45], v[70:73], v[146:149], v[42:45]
    ds_read_b128 v[66:69], v21 offset:18944
    buffer_load_dwordx4 v[146:149], v24, s[4:7], s65 offen offset:2048 sc1
    v_mfma_f32_16x16x32_bf16 v[62:65], v[70:73], v[150:153], v[62:65]
    buffer_load_dwordx4 v[150:153], v25, s[4:7], s65 offen offset:2048 sc1
    s_waitcnt vmcnt(14) lgkmcnt(7)
    v_mfma_f32_16x16x32_bf16 v[26:29], v[74:77], v[90:93], v[26:29]
    v_add_u32 v20, 0xfffe8f00, v20
    v_add_u32 v21, 0xfffe8f00, v21
    ds_read_b64_tr_b16 v[70:71], v20 offset:0
    v_mfma_f32_16x16x32_bf16 v[46:49], v[74:77], v[94:97], v[46:49]
    ds_read_b64_tr_b16 v[72:73], v20 offset:256
    s_waitcnt lgkmcnt(7)
    v_mfma_f32_16x16x32_bf16 v[30:33], v[78:81], v[90:93], v[30:33]
    ds_read_b64_tr_b16 v[74:75], v20 offset:32
    v_mfma_f32_16x16x32_bf16 v[50:53], v[78:81], v[94:97], v[50:53]
    ds_read_b64_tr_b16 v[76:77], v20 offset:288
    s_waitcnt lgkmcnt(7)
    v_mfma_f32_16x16x32_bf16 v[34:37], v[82:85], v[90:93], v[34:37]
    ds_read_b64_tr_b16 v[78:79], v20 offset:64
    v_mfma_f32_16x16x32_bf16 v[54:57], v[82:85], v[94:97], v[54:57]
    ds_read_b64_tr_b16 v[80:81], v20 offset:320
    s_waitcnt lgkmcnt(7)
    v_mfma_f32_16x16x32_bf16 v[38:41], v[86:89], v[90:93], v[38:41]
    ds_read_b64_tr_b16 v[82:83], v20 offset:96
    v_mfma_f32_16x16x32_bf16 v[58:61], v[86:89], v[94:97], v[58:61]
    ds_read_b64_tr_b16 v[84:85], v20 offset:352
    s_waitcnt lgkmcnt(8)
    v_mfma_f32_16x16x32_bf16 v[42:45], v[66:69], v[90:93], v[42:45]
    ds_read_b128 v[86:89], v21 offset:8448
    v_mfma_f32_16x16x32_bf16 v[62:65], v[66:69], v[94:97], v[62:65]
    s_barrier
    s_waitcnt vmcnt(12) lgkmcnt(7)
    v_mfma_f32_16x16x32_bf16 v[26:29], v[70:73], v[98:101], v[26:29]
    ds_read_b64_tr_b16 v[66:67], v20 offset:10496
    v_mfma_f32_16x16x32_bf16 v[46:49], v[70:73], v[102:105], v[46:49]
    ds_read_b64_tr_b16 v[68:69], v20 offset:10752
    s_waitcnt lgkmcnt(7)
    v_mfma_f32_16x16x32_bf16 v[30:33], v[74:77], v[98:101], v[30:33]
    ds_read_b64_tr_b16 v[70:71], v20 offset:10528
    v_mfma_f32_16x16x32_bf16 v[50:53], v[74:77], v[102:105], v[50:53]
    ds_read_b64_tr_b16 v[72:73], v20 offset:10784
    s_waitcnt lgkmcnt(7)
    v_mfma_f32_16x16x32_bf16 v[34:37], v[78:81], v[98:101], v[34:37]
    ds_read_b64_tr_b16 v[74:75], v20 offset:10560
    v_mfma_f32_16x16x32_bf16 v[54:57], v[78:81], v[102:105], v[54:57]
    ds_read_b64_tr_b16 v[76:77], v20 offset:10816
    s_waitcnt lgkmcnt(7)
    v_mfma_f32_16x16x32_bf16 v[38:41], v[82:85], v[98:101], v[38:41]
    ds_read_b64_tr_b16 v[78:79], v20 offset:10592
    v_mfma_f32_16x16x32_bf16 v[58:61], v[82:85], v[102:105], v[58:61]
    ds_read_b64_tr_b16 v[80:81], v20 offset:10848
    s_waitcnt lgkmcnt(8)
    v_mfma_f32_16x16x32_bf16 v[42:45], v[86:89], v[98:101], v[42:45]
    ds_read_b128 v[82:85], v21 offset:18944
    v_mfma_f32_16x16x32_bf16 v[62:65], v[86:89], v[102:105], v[62:65]
    s_waitcnt vmcnt(10) lgkmcnt(7)
    v_mfma_f32_16x16x32_bf16 v[26:29], v[66:69], v[106:109], v[26:29]
    ds_read_b64_tr_b16 v[86:87], v20 offset:20992
    v_mfma_f32_16x16x32_bf16 v[46:49], v[66:69], v[110:113], v[46:49]
    ds_read_b64_tr_b16 v[88:89], v20 offset:21248
    s_waitcnt lgkmcnt(7)
    v_mfma_f32_16x16x32_bf16 v[30:33], v[70:73], v[106:109], v[30:33]
    ds_read_b64_tr_b16 v[66:67], v20 offset:21024
    v_mfma_f32_16x16x32_bf16 v[50:53], v[70:73], v[110:113], v[50:53]
    ds_read_b64_tr_b16 v[68:69], v20 offset:21280
    s_waitcnt lgkmcnt(7)
    v_mfma_f32_16x16x32_bf16 v[34:37], v[74:77], v[106:109], v[34:37]
    ds_read_b64_tr_b16 v[70:71], v20 offset:21056
    v_mfma_f32_16x16x32_bf16 v[54:57], v[74:77], v[110:113], v[54:57]
    ds_read_b64_tr_b16 v[72:73], v20 offset:21312
    s_waitcnt lgkmcnt(7)
    v_mfma_f32_16x16x32_bf16 v[38:41], v[78:81], v[106:109], v[38:41]
    ds_read_b64_tr_b16 v[74:75], v20 offset:21088
    v_mfma_f32_16x16x32_bf16 v[58:61], v[78:81], v[110:113], v[58:61]
    ds_read_b64_tr_b16 v[76:77], v20 offset:21344
    s_waitcnt lgkmcnt(8)
    v_mfma_f32_16x16x32_bf16 v[42:45], v[82:85], v[106:109], v[42:45]
    ds_read_b128 v[78:81], v21 offset:29440
    v_mfma_f32_16x16x32_bf16 v[62:65], v[82:85], v[110:113], v[62:65]
    s_waitcnt vmcnt(8) lgkmcnt(7)
    v_mfma_f32_16x16x32_bf16 v[26:29], v[86:89], v[114:117], v[26:29]
    ds_read_b64_tr_b16 v[82:83], v20 offset:31488
    v_mfma_f32_16x16x32_bf16 v[46:49], v[86:89], v[118:121], v[46:49]
    ds_read_b64_tr_b16 v[84:85], v20 offset:31744
    s_waitcnt lgkmcnt(7)
    v_mfma_f32_16x16x32_bf16 v[30:33], v[66:69], v[114:117], v[30:33]
    ds_read_b64_tr_b16 v[86:87], v20 offset:31520
    v_mfma_f32_16x16x32_bf16 v[50:53], v[66:69], v[118:121], v[50:53]
    ds_read_b64_tr_b16 v[88:89], v20 offset:31776
    s_waitcnt lgkmcnt(7)
    v_mfma_f32_16x16x32_bf16 v[34:37], v[70:73], v[114:117], v[34:37]
    ds_read_b64_tr_b16 v[66:67], v20 offset:31552
    v_mfma_f32_16x16x32_bf16 v[54:57], v[70:73], v[118:121], v[54:57]
    ds_read_b64_tr_b16 v[68:69], v20 offset:31808
    s_waitcnt lgkmcnt(7)
    v_mfma_f32_16x16x32_bf16 v[38:41], v[74:77], v[114:117], v[38:41]
    ds_read_b64_tr_b16 v[70:71], v20 offset:31584
    v_mfma_f32_16x16x32_bf16 v[58:61], v[74:77], v[118:121], v[58:61]
    ds_read_b64_tr_b16 v[72:73], v20 offset:31840
    s_waitcnt lgkmcnt(8)
    v_mfma_f32_16x16x32_bf16 v[42:45], v[78:81], v[114:117], v[42:45]
    ds_read_b128 v[74:77], v21 offset:39936
    v_mfma_f32_16x16x32_bf16 v[62:65], v[78:81], v[118:121], v[62:65]
    s_barrier
    s_waitcnt vmcnt(6) lgkmcnt(7)
    v_mfma_f32_16x16x32_bf16 v[26:29], v[82:85], v[122:125], v[26:29]
    ds_read_b64_tr_b16 v[78:79], v20 offset:41984
    v_mfma_f32_16x16x32_bf16 v[46:49], v[82:85], v[126:129], v[46:49]
    ds_read_b64_tr_b16 v[80:81], v20 offset:42240
    s_waitcnt lgkmcnt(7)
    v_mfma_f32_16x16x32_bf16 v[30:33], v[86:89], v[122:125], v[30:33]
    ds_read_b64_tr_b16 v[82:83], v20 offset:42016
    v_mfma_f32_16x16x32_bf16 v[50:53], v[86:89], v[126:129], v[50:53]
    ds_read_b64_tr_b16 v[84:85], v20 offset:42272
    s_waitcnt lgkmcnt(7)
    v_mfma_f32_16x16x32_bf16 v[34:37], v[66:69], v[122:125], v[34:37]
    ds_read_b64_tr_b16 v[86:87], v20 offset:42048
    v_mfma_f32_16x16x32_bf16 v[54:57], v[66:69], v[126:129], v[54:57]
    ds_read_b64_tr_b16 v[88:89], v20 offset:42304
    s_waitcnt lgkmcnt(7)
    v_mfma_f32_16x16x32_bf16 v[38:41], v[70:73], v[122:125], v[38:41]
    ds_read_b64_tr_b16 v[66:67], v20 offset:42080
    v_mfma_f32_16x16x32_bf16 v[58:61], v[70:73], v[126:129], v[58:61]
    ds_read_b64_tr_b16 v[68:69], v20 offset:42336
    s_waitcnt lgkmcnt(8)
    v_mfma_f32_16x16x32_bf16 v[42:45], v[74:77], v[122:125], v[42:45]
    ds_read_b128 v[70:73], v21 offset:50432
    v_mfma_f32_16x16x32_bf16 v[62:65], v[74:77], v[126:129], v[62:65]
    s_waitcnt vmcnt(4) lgkmcnt(7)
    v_mfma_f32_16x16x32_bf16 v[26:29], v[78:81], v[130:133], v[26:29]
    ds_read_b64_tr_b16 v[74:75], v20 offset:52480
    v_mfma_f32_16x16x32_bf16 v[46:49], v[78:81], v[134:137], v[46:49]
    ds_read_b64_tr_b16 v[76:77], v20 offset:52736
    s_waitcnt lgkmcnt(7)
    v_mfma_f32_16x16x32_bf16 v[30:33], v[82:85], v[130:133], v[30:33]
    ds_read_b64_tr_b16 v[78:79], v20 offset:52512
    v_mfma_f32_16x16x32_bf16 v[50:53], v[82:85], v[134:137], v[50:53]
    ds_read_b64_tr_b16 v[80:81], v20 offset:52768
    s_waitcnt lgkmcnt(7)
    v_mfma_f32_16x16x32_bf16 v[34:37], v[86:89], v[130:133], v[34:37]
    ds_read_b64_tr_b16 v[82:83], v20 offset:52544
    v_mfma_f32_16x16x32_bf16 v[54:57], v[86:89], v[134:137], v[54:57]
    ds_read_b64_tr_b16 v[84:85], v20 offset:52800
    s_waitcnt lgkmcnt(7)
    v_mfma_f32_16x16x32_bf16 v[38:41], v[66:69], v[130:133], v[38:41]
    ds_read_b64_tr_b16 v[86:87], v20 offset:52576
    v_mfma_f32_16x16x32_bf16 v[58:61], v[66:69], v[134:137], v[58:61]
    ds_read_b64_tr_b16 v[88:89], v20 offset:52832
    s_waitcnt lgkmcnt(8)
    v_mfma_f32_16x16x32_bf16 v[42:45], v[70:73], v[130:133], v[42:45]
    ds_read_b128 v[66:69], v21 offset:60928
    v_mfma_f32_16x16x32_bf16 v[62:65], v[70:73], v[134:137], v[62:65]
    s_waitcnt vmcnt(2) lgkmcnt(7)
    v_mfma_f32_16x16x32_bf16 v[26:29], v[74:77], v[138:141], v[26:29]
    v_add_u32 v20, 0xf600, v20
    v_add_u32 v21, 0xf600, v21
    ds_read_b64_tr_b16 v[70:71], v20 offset:0
    v_mfma_f32_16x16x32_bf16 v[46:49], v[74:77], v[142:145], v[46:49]
    ds_read_b64_tr_b16 v[72:73], v20 offset:256
    s_waitcnt lgkmcnt(7)
    v_mfma_f32_16x16x32_bf16 v[30:33], v[78:81], v[138:141], v[30:33]
    ds_read_b64_tr_b16 v[74:75], v20 offset:32
    v_mfma_f32_16x16x32_bf16 v[50:53], v[78:81], v[142:145], v[50:53]
    ds_read_b64_tr_b16 v[76:77], v20 offset:288
    s_waitcnt lgkmcnt(7)
    v_mfma_f32_16x16x32_bf16 v[34:37], v[82:85], v[138:141], v[34:37]
    ds_read_b64_tr_b16 v[78:79], v20 offset:64
    v_mfma_f32_16x16x32_bf16 v[54:57], v[82:85], v[142:145], v[54:57]
    ds_read_b64_tr_b16 v[80:81], v20 offset:320
    s_waitcnt lgkmcnt(7)
    v_mfma_f32_16x16x32_bf16 v[38:41], v[86:89], v[138:141], v[38:41]
    ds_read_b64_tr_b16 v[82:83], v20 offset:96
    v_mfma_f32_16x16x32_bf16 v[58:61], v[86:89], v[142:145], v[58:61]
    ds_read_b64_tr_b16 v[84:85], v20 offset:352
    s_waitcnt lgkmcnt(8)
    v_mfma_f32_16x16x32_bf16 v[42:45], v[66:69], v[138:141], v[42:45]
    ds_read_b128 v[86:89], v21 offset:8448
    v_mfma_f32_16x16x32_bf16 v[62:65], v[66:69], v[142:145], v[62:65]
    s_waitcnt vmcnt(0) lgkmcnt(7)
    v_mfma_f32_16x16x32_bf16 v[46:49], v[70:73], v[150:153], v[46:49]
    s_waitcnt lgkmcnt(5)
    v_mfma_f32_16x16x32_bf16 v[50:53], v[74:77], v[150:153], v[50:53]
    s_waitcnt lgkmcnt(3)
    v_mfma_f32_16x16x32_bf16 v[54:57], v[78:81], v[150:153], v[54:57]
    s_waitcnt lgkmcnt(1)
    v_mfma_f32_16x16x32_bf16 v[58:61], v[82:85], v[150:153], v[58:61]
    s_waitcnt lgkmcnt(0)
    v_mfma_f32_16x16x32_bf16 v[62:65], v[86:89], v[150:153], v[62:65]
    v_mfma_f32_16x16x32_bf16 v[26:29], v[70:73], v[146:149], v[26:29]
    ds_write_b128 v23, v[46:49] offset:0
    v_mfma_f32_16x16x32_bf16 v[30:33], v[74:77], v[146:149], v[30:33]
    ds_write_b128 v23, v[50:53] offset:1024
    v_mfma_f32_16x16x32_bf16 v[34:37], v[78:81], v[146:149], v[34:37]
    ds_write_b128 v23, v[54:57] offset:2048
    v_mfma_f32_16x16x32_bf16 v[38:41], v[82:85], v[146:149], v[38:41]
    ds_write_b128 v23, v[58:61] offset:3072
    v_mfma_f32_16x16x32_bf16 v[42:45], v[86:89], v[146:149], v[42:45]
    ds_write_b128 v23, v[62:65] offset:4096
    s_bitcmp1_b32 s38, 0
    s_movk_i32 s52, 5120
    s_cmovk_i32 s52, 60416
    v_add_u32 v14, s52, v23
    s_waitcnt lgkmcnt(0)
    s_barrier
    ds_read_b128 v[46:49], v14 offset:0
    ds_read_b128 v[50:53], v14 offset:1024
    ds_read_b128 v[54:57], v14 offset:2048
    ds_read_b128 v[58:61], v14 offset:3072
    ds_read_b128 v[62:65], v14 offset:4096
    s_waitcnt lgkmcnt(4)
    v_pk_add_f32 v[26:27], v[26:27], v[46:47]
    v_pk_add_f32 v[28:29], v[28:29], v[48:49]
    v_cvt_pk_bf16_f32 v2, v26, v27
    v_cvt_pk_bf16_f32 v3, v28, v29
    s_waitcnt lgkmcnt(3)
    v_pk_add_f32 v[30:31], v[30:31], v[50:51]
    v_pk_add_f32 v[32:33], v[32:33], v[52:53]
    v_cvt_pk_bf16_f32 v4, v30, v31
    v_cvt_pk_bf16_f32 v5, v32, v33
    s_nop 0
    v_permlane16_swap_b32 v2, v4
    v_permlane16_swap_b32 v3, v5
    buffer_store_dwordx4 v[2:5], v18, s[12:15], s73 offen offset:0
    s_waitcnt lgkmcnt(2)
    v_pk_add_f32 v[34:35], v[34:35], v[54:55]
    v_pk_add_f32 v[36:37], v[36:37], v[56:57]
    v_cvt_pk_bf16_f32 v6, v34, v35
    v_cvt_pk_bf16_f32 v7, v36, v37
    s_waitcnt lgkmcnt(1)
    v_pk_add_f32 v[38:39], v[38:39], v[58:59]
    v_pk_add_f32 v[40:41], v[40:41], v[60:61]
    v_cvt_pk_bf16_f32 v8, v38, v39
    v_cvt_pk_bf16_f32 v9, v40, v41
    s_nop 0
    v_permlane16_swap_b32 v6, v8
    v_permlane16_swap_b32 v7, v9
    buffer_store_dwordx4 v[6:9], v18, s[12:15], s73 offen offset:64
    s_waitcnt lgkmcnt(0)
    v_pk_add_f32 v[42:43], v[42:43], v[62:63]
    v_pk_add_f32 v[44:45], v[44:45], v[64:65]
    v_cvt_pk_bf16_f32 v10, v42, v43
    v_cvt_pk_bf16_f32 v11, v44, v45
    buffer_store_dwordx2 v[10:11], v19, s[12:15], s74 offen
    s_endpgm
.helper_66:
    s_sub_u32 s52, s38, 4
    s_setprio 0
    s_mov_b32 s8, s28
    s_and_b32 s9, s29, 0xffff
    s_mov_b32 s10, 1966080
    s_mov_b32 s11, 0x00020000
    s_lshr_b32 s53, s44, 2
    s_add_u32 s53, s53, s44
    s_lshl_b32 s53, s53, 7
    v_and_b32 v2, 7, v0
    v_lshlrev_b32 v2, 4, v2
    v_lshrrev_b32 v3, 5, v0
    v_bfe_u32 v4, v0, 4, 1
    v_bfe_u32 v5, v0, 3, 1
    s_mul_i32 s54, s52, 2560
    s_add_u32 s54, s54, s53
    v_mul_u32_u24 v9, 983040, v3
    v_mul_u32_u24 v10, 10240, v4
    v_add3_u32 v9, v9, v10, v2
    v_mul_u32_u24 v10, 20480, v5
    v_add3_u32 v9, v9, v10, s54
    s_and_b32 s53, s52, 1
    s_lshl1_add_u32 s55, s44, s53
    s_mul_i32 s55, s55, 24576
    s_lshr_b32 s54, s52, 1
    s_lshl_b32 s54, s54, 9
    s_add_u32 s55, s55, 21233664
    v_lshl_add_u32 v6, v0, 3, s54
    s_lshl_b32 s53, s53, 10
    v_add_u32 v8, s53, v6
    s_mul_i32 s53, s52, 2112
    v_add_u32 v7, s53, v1
    s_and_b32 s56, s43, 3
    s_mul_i32 s56, s56, 6
    s_barrier
    s_add_u32 s53, s56, 15
    s_sub_u32 s54, s53, 24
    s_cselect_b32 s53, s53, s54
    s_lshl_b32 s54, s53, 10
    s_mul_i32 s53, s53, 40960
    s_add_u32 s54, s54, s55
    s_waitcnt vmcnt(3)
    buffer_load_dwordx4 v[12:15], v9, s[8:11], s53 offen offset:0
    s_waitcnt vmcnt(3)
    buffer_load_dwordx4 v[16:19], v9, s[8:11], s53 offen offset:1280
    buffer_load_dwordx2 v[20:21], v6, s[4:7], s54 offen sc1
    s_add_u32 s53, s56, 16
    s_sub_u32 s54, s53, 24
    s_cselect_b32 s53, s53, s54
    s_lshl_b32 s54, s53, 10
    s_mul_i32 s53, s53, 40960
    s_add_u32 s54, s54, s55
    s_waitcnt vmcnt(3)
    buffer_load_dwordx4 v[22:25], v9, s[8:11], s53 offen offset:0
    s_waitcnt vmcnt(3)
    buffer_load_dwordx4 v[26:29], v9, s[8:11], s53 offen offset:1280
    buffer_load_dwordx2 v[30:31], v6, s[4:7], s54 offen sc1
    s_barrier
    s_barrier
    s_barrier
    s_barrier
    s_barrier
    s_add_u32 s53, s56, 17
    s_sub_u32 s54, s53, 24
    s_cselect_b32 s53, s53, s54
    s_lshl_b32 s54, s53, 10
    s_mul_i32 s53, s53, 40960
    s_add_u32 s54, s54, s55
    s_waitcnt vmcnt(3)
    buffer_load_dwordx4 v[32:35], v9, s[8:11], s53 offen offset:0
    s_waitcnt vmcnt(3)
    buffer_load_dwordx4 v[36:39], v9, s[8:11], s53 offen offset:1280
    buffer_load_dwordx2 v[40:41], v6, s[4:7], s54 offen sc1
    s_waitcnt vmcnt(3)
    s_waitcnt lgkmcnt(0)
    s_barrier
    v_add_u32 v7, 0x17100, v7
    v_add_u32 v8, 0x17100, v8
    ds_write_b128 v7, v[12:15] offset:0
    ds_write_b128 v7, v[16:19] offset:1056
    ds_write_b64 v8, v[20:21] offset:8448
    ds_write_b128 v7, v[22:25] offset:10496
    ds_write_b128 v7, v[26:29] offset:11552
    ds_write_b64 v8, v[30:31] offset:18944
    s_waitcnt lgkmcnt(0)
    s_barrier
    s_waitcnt vmcnt(0)
    v_add_u32 v7, 0xfffe8f00, v7
    v_add_u32 v8, 0xfffe8f00, v8
    ds_write_b128 v7, v[32:35] offset:0
    ds_write_b128 v7, v[36:39] offset:1056
    ds_write_b64 v8, v[40:41] offset:8448
    s_waitcnt lgkmcnt(0)
    s_barrier
    s_waitcnt lgkmcnt(0)
    s_barrier
    s_waitcnt lgkmcnt(0)
    s_barrier
    s_endpgm
.cap_22:
    v_add_u32 v2, 33792, v141
    v_xor_b32 v4, 32, v2
    v_xor_b32 v6, 64, v2
    v_xor_b32 v8, 96, v2
    ds_read_b64 v[2:3], v2
    ds_read_b64 v[4:5], v4
    ds_read_b64 v[6:7], v6
    ds_read_b64 v[8:9], v8
    s_branch .capb_23
.cap_24:
    v_add_u32 v10, 33792, v141
    v_xor_b32 v10, s57, v10
    ds_read_b64 v[10:11], v10
    s_branch .capb_25
.cap_27:
    v_add_u32 v2, 77824, v141
    v_xor_b32 v4, 32, v2
    v_xor_b32 v6, 64, v2
    v_xor_b32 v8, 96, v2
    ds_read_b64 v[2:3], v2
    ds_read_b64 v[4:5], v4
    ds_read_b64 v[6:7], v6
    ds_read_b64 v[8:9], v8
    s_branch .capb_28
.cap_29:
    v_add_u32 v10, 77824, v141
    v_xor_b32 v10, s57, v10
    ds_read_b64 v[10:11], v10
    s_branch .capb_30
.cap_31:
    v_add_u32 v2, 121856, v141
    v_xor_b32 v4, 32, v2
    v_xor_b32 v6, 64, v2
    v_xor_b32 v8, 96, v2
    ds_read_b64 v[2:3], v2
    ds_read_b64 v[4:5], v4
    ds_read_b64 v[6:7], v6
    ds_read_b64 v[8:9], v8
    s_branch .capb_32
.cap_33:
    v_add_u32 v10, 121856, v141
    v_xor_b32 v10, s57, v10
    ds_read_b64 v[10:11], v10
    s_branch .capb_34
.cap_35:
    v_add_u32 v2, 33792, v141
    v_xor_b32 v4, 32, v2
    v_xor_b32 v6, 64, v2
    v_xor_b32 v8, 96, v2
    ds_read_b64 v[2:3], v2
    ds_read_b64 v[4:5], v4
    ds_read_b64 v[6:7], v6
    ds_read_b64 v[8:9], v8
    s_branch .capb_36
.cap_37:
    v_add_u32 v10, 33792, v141
    v_xor_b32 v10, s57, v10
    ds_read_b64 v[10:11], v10
    s_branch .capb_38
.cap_39:
    v_add_u32 v2, 77824, v141
    v_xor_b32 v4, 32, v2
    v_xor_b32 v6, 64, v2
    v_xor_b32 v8, 96, v2
    ds_read_b64 v[2:3], v2
    ds_read_b64 v[4:5], v4
    ds_read_b64 v[6:7], v6
    ds_read_b64 v[8:9], v8
    s_branch .capb_40
.cap_41:
    v_add_u32 v10, 77824, v141
    v_xor_b32 v10, s57, v10
    ds_read_b64 v[10:11], v10
    s_branch .capb_42
.cap_43:
    v_add_u32 v2, 121856, v141
    v_xor_b32 v4, 32, v2
    v_xor_b32 v6, 64, v2
    v_xor_b32 v8, 96, v2
    ds_read_b64 v[2:3], v2
    ds_read_b64 v[4:5], v4
    ds_read_b64 v[6:7], v6
    ds_read_b64 v[8:9], v8
    s_branch .capb_44
.cap_45:
    v_add_u32 v10, 121856, v141
    v_xor_b32 v10, s57, v10
    ds_read_b64 v[10:11], v10
    s_branch .capb_46
.cap_47:
    v_add_u32 v2, 33792, v141
    v_xor_b32 v4, 32, v2
    v_xor_b32 v6, 64, v2
    v_xor_b32 v8, 96, v2
    ds_read_b64 v[2:3], v2
    ds_read_b64 v[4:5], v4
    ds_read_b64 v[6:7], v6
    ds_read_b64 v[8:9], v8
    s_branch .capb_48
.cap_49:
    v_add_u32 v10, 33792, v141
    v_xor_b32 v10, s57, v10
    ds_read_b64 v[10:11], v10
    s_branch .capb_50
.cap_51:
    v_add_u32 v2, 77824, v141
    v_xor_b32 v4, 32, v2
    v_xor_b32 v6, 64, v2
    v_xor_b32 v8, 96, v2
    ds_read_b64 v[2:3], v2
    ds_read_b64 v[4:5], v4
    ds_read_b64 v[6:7], v6
    ds_read_b64 v[8:9], v8
    s_branch .capb_52
.cap_53:
    v_add_u32 v10, 77824, v141
    v_xor_b32 v10, s57, v10
    ds_read_b64 v[10:11], v10
    s_branch .capb_54
.cap_55:
    v_add_u32 v2, 121856, v141
    v_xor_b32 v4, 32, v2
    v_xor_b32 v6, 64, v2
    v_xor_b32 v8, 96, v2
    ds_read_b64 v[2:3], v2
    ds_read_b64 v[4:5], v4
    ds_read_b64 v[6:7], v6
    ds_read_b64 v[8:9], v8
    s_branch .capb_56
.cap_57:
    v_add_u32 v10, 121856, v141
    v_xor_b32 v10, s57, v10
    ds_read_b64 v[10:11], v10
    s_branch .capb_58
.cap_59:
    v_add_u32 v2, 33792, v141
    v_xor_b32 v4, 32, v2
    v_xor_b32 v6, 64, v2
    v_xor_b32 v8, 96, v2
    ds_read_b64 v[2:3], v2
    ds_read_b64 v[4:5], v4
    ds_read_b64 v[6:7], v6
    ds_read_b64 v[8:9], v8
    s_branch .capb_60
.cap_61:
    v_add_u32 v10, 33792, v141
    v_xor_b32 v10, s57, v10
    ds_read_b64 v[10:11], v10
    s_branch .capb_62
.slow_64:
    buffer_store_dword v14, off, s[4:7], s60 sc1
    s_branch .join_65
.slow_69:
    buffer_store_dword v14, off, s[4:7], s78 sc1
    s_branch .join_70
.slow_73:
    buffer_store_dword v14, off, s[4:7], s84 sc1
    s_branch .join_74
.section .rodata,"a"
.p2align 6
.amdhsa_kernel sequential_preLN__sliding_local_dilated__dense_activation_squared_relu__prompt_kernel
  .amdhsa_next_free_vgpr 168
  .amdhsa_next_free_sgpr 102
  .amdhsa_accum_offset 168
  .amdhsa_group_segment_fixed_size 0
  .amdhsa_kernarg_size 88
  .amdhsa_user_sgpr_count 2
  .amdhsa_user_sgpr_kernarg_segment_ptr 1
  .amdhsa_system_sgpr_workgroup_id_x 1
.end_amdhsa_kernel
```
